```python
import torch

def _softmax(x, axis=-1):
    return torch.softmax(x, dim=axis)

def _gelu(x):
    return torch.nn.functional.gelu(x, approximate='tanh')

def _silu(x):
    return torch.nn.functional.silu(x)

def _sigmoid(x):
    return torch.sigmoid(x)

def _layernorm(x, axis=-1, eps=1e-05):
    m = x.mean(dim=axis, keepdim=True)
    v = x.var(dim=axis, keepdim=True, unbiased=False)
    return (x - m) / torch.sqrt(v + eps)

def _scatter_add(tgt, idx, src, axis=0):
    return tgt.clone().index_add_(axis, idx, src)

def _segment_sum(src, seg, n):
    out = torch.zeros((n,) + src.shape[1:], dtype=src.dtype)
    return out.index_add_(0, seg, src)

def _pad(x, pw):
    flat = tuple((v for pair in reversed(pw) for v in pair))
    return torch.nn.functional.pad(x, flat)
kernel_name = 'standalone__factorization_afm__recsys'

def setup_inputs():

    _w = lambda a: (lambda t: t.to(torch.bfloat16) if t.is_floating_point() else t)(torch.as_tensor(a))
    B, F, D, V = (16384, 26, 32, min(1000, 100000))
    A = D
    ii, jj = tuple(torch.triu_indices(F, F, 1).unbind(0))
    return {'idx': _w((lambda lo, hi, *s: torch.randint(lo, hi, s))(0, V, B, F).to(torch.int64)), 'table': _w((lambda *s: torch.randn(*s, dtype=torch.bfloat16) * 0.4)(V, D)), 'ii': _w(ii.to(torch.int64)), 'jj': _w(jj.to(torch.int64)), 'W': _w((lambda *s: torch.randn(*s, dtype=torch.bfloat16) * 1.6)(D, A) * (1.0 / D ** 0.5)), 'b': _w((lambda *s: torch.randn(*s, dtype=torch.bfloat16) * 1.6)(A)), 'h': _w((lambda *s: torch.randn(*s, dtype=torch.bfloat16) * 1.6)(A)), 'p': _w((lambda *s: torch.randn(*s, dtype=torch.bfloat16) * 0.2)(D))}

def reference(idx, table, ii, jj, W, b, h, p):
    emb = table[idx]
    ei = emb[:, ii, :].clone()
    ej = emb[:, jj, :].clone()
    pair = ei * ej
    hid = pair @ W + b
    hid = 0.5 * (hid + torch.abs(hid))
    e = hid @ h
    alpha = _softmax(e, axis=-1)
    pooled = torch.einsum('bp,bpd->bd', alpha, pair)
    return pooled @ p
```

```asm
; @launch grid=(256,1,1) block=(768,1,1) lds=163840
.amdgcn_target "amdgcn-amd-amdhsa--gfx950"
.text
.globl standalone__factorization_afm__recsys_kernel
.p2align 8
.type standalone__factorization_afm__recsys_kernel,@function
standalone__factorization_afm__recsys_kernel:
  s_cmp_ge_u32 s2, 256
  s_cbranch_scc1 L_end
  s_load_dwordx4 s[4:7], s[0:1], 0
  s_load_dwordx8 s[8:15], s[0:1], 32
  s_load_dwordx2 s[18:19], s[0:1], 80
  s_load_dwordx2 s[16:17], s[0:1], 64
  v_lshrrev_b32 v2, 6, v0
  v_and_b32 v1, 63, v0
  v_readfirstlane_b32 s20, v2
  s_and_b32 s57, s2, 7
  s_lshl_b32 s57, s57, 5
  s_lshr_b32 s58, s2, 3
  s_add_u32 s57, s57, s58
  s_cmp_ge_u32 s20, 8
  s_cbranch_scc0 L_S
  s_getpc_b64 s[50:51]
L_pc:
  s_sub_u32 s50, s50, L_pc-standalone__factorization_afm__recsys_kernel
  s_subb_u32 s51, s51, 0
  v_subrev_u32 v3, 512, v0
  v_lshlrev_b32 v3, 7, v3
  v_min_u32 v3, L_slow-standalone__factorization_afm__recsys_kernel, v3
  global_load_dword v53, v3, s[50:51]
  s_branch L_T
L_S:
  s_setprio 2
  v_lshlrev_b32 v3, 4, v0
  s_mul_i32 s21, s2, 6656
  v_mov_b32 v126, 0
  v_mov_b32 v127, 1
  s_cmp_eq_u32 s20, 7
  s_cbranch_scc0 L_no7a
  v_mov_b32 v22, 0
  v_mov_b32 v23, 0
  v_mov_b32 v24, 0
  v_mov_b32 v25, 0
  v_lshlrev_b32 v26, 4, v1
  v_lshlrev_b32 v27, 1, v1
  v_and_b32 v27, 0x7c, v27
  ds_write_b128 v26, v[22:25] offset:61440
  ds_write_b32 v27, v22 offset:62464
L_no7a:
  s_waitcnt lgkmcnt(0)
  s_add_u32 s24, s4, s21
  s_addc_u32 s25, s5, 0
  s_and_b32 s25, s25, 0xffff
  s_mov_b32 s26, 6656
  s_mov_b32 s27, 0x00020000

  buffer_load_dwordx4 v[4:7], v3, s[24:27], 0 offen
  s_add_u32 s28, s18, 0
  s_addc_u32 s29, s19, 0
  s_and_b32 s29, s29, 0xffff
  s_mov_b32 s30, 528384
  s_mov_b32 s31, 0x00020000
  buffer_load_dword v8, v126, s[28:31], 0 offen sc1
  s_barrier
  s_add_u32 s32, s18, 1048576
  s_addc_u32 s33, s19, 0
  s_and_b32 s33, s33, 0xffff
  s_mov_b32 s34, 7340032
  s_mov_b32 s35, 0x00020000
  s_add_u32 s36, s18, 9437184
  s_addc_u32 s37, s19, 0
  s_and_b32 s37, s37, 0xffff
  s_mov_b32 s38, 6029312
  s_mov_b32 s39, 0x00020000
  s_mov_b32 s40, s16
  s_and_b32 s41, s17, 0xffff
  s_mov_b32 s42, 32768
  s_mov_b32 s43, 0x00020000
  s_cmp_eq_u32 s20, 7
  s_cbranch_scc0 L_no7b
  v_lshlrev_b32 v14, 4, v1
  v_mov_b32 v10, -1
  v_mov_b32 v11, -1
  v_mov_b32 v12, -1
  v_mov_b32 v13, -1
  s_mul_i32 s22, s2, 23552
L_sw1:
  ds_read_b32 v9, v126 offset:62464
  s_waitcnt lgkmcnt(0)
  v_cmp_gt_u32 vcc, 7, v9
  s_cbranch_vccz L_sx1
  s_sleep 1
  s_branch L_sw1
L_sx1:
  buffer_store_dwordx4 v[10:13], v14, s[36:39], s22 offen offset:0 sc1
  buffer_store_dwordx4 v[10:13], v14, s[36:39], s22 offen offset:1024 sc1
  buffer_store_dwordx4 v[10:13], v14, s[36:39], s22 offen offset:2048 sc1
  buffer_store_dwordx4 v[10:13], v14, s[36:39], s22 offen offset:3072 sc1
  s_add_u32 s22, s22, 4096
  buffer_store_dwordx4 v[10:13], v14, s[36:39], s22 offen offset:0 sc1
  buffer_store_dwordx4 v[10:13], v14, s[36:39], s22 offen offset:1024 sc1
  buffer_store_dwordx4 v[10:13], v14, s[36:39], s22 offen offset:2048 sc1
  buffer_store_dwordx4 v[10:13], v14, s[36:39], s22 offen offset:3072 sc1
  s_add_u32 s22, s22, 4096
  buffer_store_dwordx4 v[10:13], v14, s[36:39], s22 offen offset:0 sc1
  buffer_store_dwordx4 v[10:13], v14, s[36:39], s22 offen offset:1024 sc1
  buffer_store_dwordx4 v[10:13], v14, s[36:39], s22 offen offset:2048 sc1
  buffer_store_dwordx4 v[10:13], v14, s[36:39], s22 offen offset:3072 sc1
  s_add_u32 s22, s22, 4096
  buffer_store_dwordx4 v[10:13], v14, s[36:39], s22 offen offset:0 sc1
  buffer_store_dwordx4 v[10:13], v14, s[36:39], s22 offen offset:1024 sc1
  buffer_store_dwordx4 v[10:13], v14, s[36:39], s22 offen offset:2048 sc1
  buffer_store_dwordx4 v[10:13], v14, s[36:39], s22 offen offset:3072 sc1
  s_add_u32 s22, s22, 4096
  buffer_store_dwordx4 v[10:13], v14, s[36:39], s22 offen offset:0 sc1
  s_waitcnt vmcnt(17)
  v_add_u32 v8, 1, v8
  s_branch L_packed
L_no7b:
  v_lshlrev_b32 v22, 2, v0
  v_mov_b32 v30, 62592
  v_add_u32 v23, 0, v22

  v_mul_u32_u24 v24, 2521, v23
  v_lshrrev_b32 v24, 16, v24
  v_mul_u32_u24 v25, 26, v24
  v_sub_u32 v25, v23, v25
  v_mul_u32_u24 v24, 176, v24
  v_add_u32 v24, v30, v24
  v_subrev_u32 v26, 1, v25
  v_min_u32 v27, 40, v26
  v_lshl_add_u32 v14, v27, 2, v24
  v_add_u32 v27, 25, v26
  v_cmp_gt_u32 vcc, 15, v26
  v_mov_b32 v28, 43
  s_nop 0
  v_cndmask_b32 v27, v28, v27, vcc
  v_lshl_add_u32 v18, v27, 2, v24
  v_add_u32 v23, 1, v22

  v_mul_u32_u24 v24, 2521, v23
  v_lshrrev_b32 v24, 16, v24
  v_mul_u32_u24 v25, 26, v24
  v_sub_u32 v25, v23, v25
  v_mul_u32_u24 v24, 176, v24
  v_add_u32 v24, v30, v24
  v_subrev_u32 v26, 1, v25
  v_min_u32 v27, 40, v26
  v_lshl_add_u32 v15, v27, 2, v24
  v_add_u32 v27, 25, v26
  v_cmp_gt_u32 vcc, 15, v26
  v_mov_b32 v28, 43
  s_nop 0
  v_cndmask_b32 v27, v28, v27, vcc
  v_lshl_add_u32 v19, v27, 2, v24
  v_add_u32 v23, 2, v22

  v_mul_u32_u24 v24, 2521, v23
  v_lshrrev_b32 v24, 16, v24
  v_mul_u32_u24 v25, 26, v24
  v_sub_u32 v25, v23, v25
  v_mul_u32_u24 v24, 176, v24
  v_add_u32 v24, v30, v24
  v_subrev_u32 v26, 1, v25
  v_min_u32 v27, 40, v26
  v_lshl_add_u32 v16, v27, 2, v24
  v_add_u32 v27, 25, v26
  v_cmp_gt_u32 vcc, 15, v26
  v_mov_b32 v28, 43
  s_nop 0
  v_cndmask_b32 v27, v28, v27, vcc
  v_lshl_add_u32 v20, v27, 2, v24
  v_add_u32 v23, 3, v22

  v_mul_u32_u24 v24, 2521, v23
  v_lshrrev_b32 v24, 16, v24
  v_mul_u32_u24 v25, 26, v24
  v_sub_u32 v25, v23, v25
  v_mul_u32_u24 v24, 176, v24
  v_add_u32 v24, v30, v24
  v_subrev_u32 v26, 1, v25
  v_min_u32 v27, 40, v26
  v_lshl_add_u32 v17, v27, 2, v24
  v_add_u32 v27, 25, v26
  v_cmp_gt_u32 vcc, 15, v26
  v_mov_b32 v28, 43
  s_nop 0
  v_cndmask_b32 v27, v28, v27, vcc
  v_lshl_add_u32 v21, v27, 2, v24
  v_mul_u32_u24 v2, 176, v1
  s_lshl_b32 s21, s20, 4
  s_cmp_eq_u32 s20, 6
  s_cselect_b32 s21, 0, s21
  v_add_u32 v2, s21, v2
  v_cmp_gt_u32 vcc, 416, v0
  s_and_saveexec_b64 s[50:51], vcc
  s_waitcnt vmcnt(0)
  ds_write_b32 v14, v4
  ds_write_b32 v18, v4
  ds_write_b32 v15, v5
  ds_write_b32 v19, v5
  ds_write_b32 v16, v6
  ds_write_b32 v20, v6
  ds_write_b32 v17, v7
  ds_write_b32 v21, v7
  s_mov_b64 exec, 1
  ds_add_u32 v126, v127 offset:62464
  s_mov_b64 exec, -1
  v_add_u32 v8, 1, v8
L_sw2:
  ds_read_b32 v9, v126 offset:62464
  s_waitcnt lgkmcnt(0)
  v_cmp_gt_u32 vcc, 7, v9
  s_cbranch_vccnz L_sw2
  s_cmp_eq_u32 s20, 6
  s_cbranch_scc1 L_w6
  ds_read_b128 v[58:61], v2 offset:62592
  ds_read_b128 v[62:65], v2 offset:62608
  ds_read_b128 v[66:69], v2 offset:62624
  ds_read_b128 v[70:73], v2 offset:62640
  s_waitcnt lgkmcnt(3)
  v_and_b32 v4, 0x3fc, v58
  ds_add_rtn_u32 v14, v4, v127 offset:61440
  v_and_b32 v5, 0x3fc, v59
  ds_add_rtn_u32 v15, v5, v127 offset:61440
  v_and_b32 v6, 0x3fc, v60
  ds_add_rtn_u32 v16, v6, v127 offset:61440
  v_and_b32 v7, 0x3fc, v61
  ds_add_rtn_u32 v17, v7, v127 offset:61440
  s_mov_b64 exec, 1
  ds_add_u32 v126, v127 offset:62468
  s_mov_b64 exec, -1
  s_waitcnt lgkmcnt(5)
  v_lshl_or_b32 v40, v60, 10, v59
  v_lshl_or_b32 v40, v61, 20, v40
  v_lshl_or_b32 v40, v58, 30, v40
  v_alignbit_b32 v40, v40, v40, 29
  v_lshl_or_b32 v41, v63, 10, v62
  v_lshl_or_b32 v41, v64, 20, v41
  v_alignbit_b32 v41, v41, v41, 29
  v_lshl_or_b32 v42, v66, 10, v65
  v_lshl_or_b32 v42, v67, 20, v42
  v_alignbit_b32 v42, v42, v42, 29
  v_lshl_or_b32 v43, v69, 10, v68
  v_lshl_or_b32 v43, v70, 20, v43
  v_alignbit_b32 v43, v43, v43, 29
  v_lshl_or_b32 v44, v61, 10, v60
  v_lshl_or_b32 v44, v62, 20, v44
  v_lshl_or_b32 v44, v59, 30, v44
  v_alignbit_b32 v44, v44, v44, 29
  v_lshl_or_b32 v45, v64, 10, v63
  v_lshl_or_b32 v45, v65, 20, v45
  v_alignbit_b32 v45, v45, v45, 29
  v_lshl_or_b32 v46, v67, 10, v66
  v_lshl_or_b32 v46, v68, 20, v46
  v_alignbit_b32 v46, v46, v46, 29
  v_lshl_or_b32 v47, v70, 10, v69
  v_lshl_or_b32 v47, v71, 20, v47
  v_alignbit_b32 v47, v47, v47, 29
  v_lshl_or_b32 v48, v62, 10, v61
  v_lshl_or_b32 v48, v63, 20, v48
  v_lshl_or_b32 v48, v60, 30, v48
  v_alignbit_b32 v48, v48, v48, 29
  v_lshl_or_b32 v49, v65, 10, v64
  v_lshl_or_b32 v49, v66, 20, v49
  v_alignbit_b32 v49, v49, v49, 29
  v_lshl_or_b32 v50, v68, 10, v67
  v_lshl_or_b32 v50, v69, 20, v50
  v_alignbit_b32 v50, v50, v50, 29
  v_lshl_or_b32 v51, v71, 10, v70
  v_lshl_or_b32 v51, v72, 20, v51
  v_alignbit_b32 v51, v51, v51, 29
  v_lshl_or_b32 v52, v63, 10, v62
  v_lshl_or_b32 v52, v64, 20, v52
  v_lshl_or_b32 v52, v61, 30, v52
  v_alignbit_b32 v52, v52, v52, 29
  v_mov_b32 v53, v42
  v_mov_b32 v54, v43
  v_lshl_or_b32 v55, v72, 10, v71
  v_lshl_or_b32 v55, v73, 20, v55
  v_alignbit_b32 v55, v55, v55, 29
  s_branch L_packed
L_w6:
  ds_read_b32 v86, v2 offset:62752
  ds_read_b128 v[82:85], v2 offset:62688
  ds_read_b128 v[58:61], v2 offset:62592
  ds_read_b128 v[62:65], v2 offset:62608
  ds_read_b128 v[66:69], v2 offset:62624
  ds_read_b128 v[70:73], v2 offset:62640
  ds_read_b128 v[74:77], v2 offset:62656
  ds_read_b128 v[78:81], v2 offset:62672
  s_waitcnt lgkmcnt(6)
  v_and_b32 v4, 0x3fc, v82
  v_and_b32 v5, 0x3fc, v86
  v_mov_b32 v6, v5
  v_mov_b32 v7, v5
  v_mov_b32 v87, 3
  ds_add_rtn_u32 v14, v4, v127 offset:61440
  ds_add_rtn_u32 v15, v5, v87 offset:61440
  s_mov_b64 exec, 1
  ds_add_u32 v126, v127 offset:62468
  s_mov_b64 exec, -1
  s_waitcnt lgkmcnt(3)
  v_mov_b32 v87, 0x3ff
  v_lshl_or_b32 v40, v59, 10, v58
  v_lshl_or_b32 v40, v60, 20, v40
  v_lshl_or_b32 v40, v82, 30, v40
  v_alignbit_b32 v40, v40, v40, 29
  v_lshl_or_b32 v41, v62, 10, v61
  v_lshl_or_b32 v41, v63, 20, v41
  v_alignbit_b32 v41, v41, v41, 29
  v_lshl_or_b32 v42, v65, 10, v64
  v_lshl_or_b32 v42, v66, 20, v42
  v_alignbit_b32 v42, v42, v42, 29
  v_lshl_or_b32 v43, v68, 10, v67
  v_lshl_or_b32 v43, v69, 20, v43
  v_alignbit_b32 v43, v43, v43, 29
  v_lshl_or_b32 v44, v59, 10, v58
  v_lshl_or_b32 v44, v60, 20, v44
  v_lshl_or_b32 v44, v86, 30, v44
  v_alignbit_b32 v44, v44, v44, 29
  v_mov_b32 v45, v41
  v_mov_b32 v46, v42
  v_mov_b32 v47, v43
  v_lshl_or_b32 v48, v71, 10, v70
  v_lshl_or_b32 v48, v72, 20, v48
  v_lshl_or_b32 v48, v86, 30, v48
  v_alignbit_b32 v48, v48, v48, 29
  v_lshl_or_b32 v49, v74, 10, v73
  v_lshl_or_b32 v49, v75, 20, v49
  v_alignbit_b32 v49, v49, v49, 29
  v_lshl_or_b32 v50, v77, 10, v76
  v_lshl_or_b32 v50, v78, 20, v50
  v_alignbit_b32 v50, v50, v50, 29
  v_lshl_or_b32 v51, v80, 10, v79
  v_lshl_or_b32 v51, v81, 20, v51
  v_alignbit_b32 v51, v51, v51, 29
  v_lshl_or_b32 v52, v87, 10, v82
  v_lshl_or_b32 v52, v87, 20, v52
  v_lshl_or_b32 v52, v86, 30, v52
  v_alignbit_b32 v52, v52, v52, 29
  v_lshl_or_b32 v53, v87, 10, v87
  v_lshl_or_b32 v53, v87, 20, v53
  v_alignbit_b32 v53, v53, v53, 29
  v_mov_b32 v54, v53
  v_mov_b32 v55, v53
  s_waitcnt lgkmcnt(0)
  v_add_u32 v16, 1, v15
  v_add_u32 v17, 2, v15
L_packed:
  v_lshlrev_b32 v2, 4, v1
  s_lshl_b32 s21, s20, 10
  s_add_u32 s21, s21, 73856
  v_add_u32 v3, s21, v2
  s_add_u32 s59, s2, s20
  s_and_b32 s59, s59, 7
  s_lshl_b32 s60, s59, 3
L_sw3:
  ds_read_b32 v9, v126 offset:62468
  s_waitcnt lgkmcnt(0)
  v_cmp_gt_u32 vcc, 7, v9
  s_cbranch_vccnz L_sw3
  ds_read_b128 v[20:23], v2 offset:61440
  s_waitcnt lgkmcnt(0)
  v_add_u32 v9, 15, v20
  v_and_b32 v9, 0xfff0, v9
  v_lshl_or_b32 v20, v9, 12, v20
  v_add_u32 v9, 15, v21
  v_and_b32 v9, 0xfff0, v9
  v_lshl_or_b32 v21, v9, 12, v21
  v_add_u32 v9, 15, v22
  v_and_b32 v9, 0xfff0, v9
  v_lshl_or_b32 v22, v9, 12, v22
  v_add_u32 v9, 15, v23
  v_and_b32 v9, 0xfff0, v9
  v_lshl_or_b32 v23, v9, 12, v23
  v_add_u32 v28, v20, v21
  v_add3_u32 v28, v28, v22, v23
  v_mov_b32 v29, v28
  s_nop 1
  v_add_u32_dpp v29, v29, v29 row_shr:1 row_mask:0xf bank_mask:0xf
  s_nop 1
  v_add_u32_dpp v29, v29, v29 row_shr:2 row_mask:0xf bank_mask:0xf
  s_nop 1
  v_add_u32_dpp v29, v29, v29 row_shr:4 row_mask:0xf bank_mask:0xf
  s_nop 1
  v_add_u32_dpp v29, v29, v29 row_shr:8 row_mask:0xf bank_mask:0xf
  s_nop 1
  v_add_u32_dpp v29, v29, v29 row_bcast:15 row_mask:0xa bank_mask:0xf
  s_nop 1
  v_add_u32_dpp v29, v29, v29 row_bcast:31 row_mask:0xc bank_mask:0xf
  v_sub_u32 v24, v29, v28
  v_add_u32 v25, v24, v20
  v_add_u32 v26, v25, v21
  v_add_u32 v27, v26, v22
  s_cmp_eq_u32 s20, 7
  s_cbranch_scc0 L_dostage
  v_readlane_b32 s48, v29, 63
  s_mul_i32 s22, s2, 23552
  s_add_u32 s22, s22, 17408
  s_lshr_b32 s48, s48, 16
  s_cmp_le_u32 s48, 272
  s_cbranch_scc1 L_noxclr
  buffer_store_dwordx4 v[10:13], v14, s[36:39], s22 offen offset:0 sc1
  buffer_store_dwordx4 v[10:13], v14, s[36:39], s22 offen offset:1024 sc1
  buffer_store_dwordx4 v[10:13], v14, s[36:39], s22 offen offset:2048 sc1
  buffer_store_dwordx4 v[10:13], v14, s[36:39], s22 offen offset:3072 sc1
  s_add_u32 s22, s22, 4096
  buffer_store_dwordx4 v[10:13], v14, s[36:39], s22 offen offset:0 sc1
  buffer_store_dwordx4 v[10:13], v14, s[36:39], s22 offen offset:1024 sc1
L_noxclr:
  s_waitcnt vmcnt(0)
  s_mov_b64 exec, 1
  ds_add_u32 v126, v127 offset:62484
  s_mov_b64 exec, -1
  s_branch L_staged
L_dostage:
  ds_write_b128 v3, v[24:27]
  v_add_u32 v4, s21, v4
  v_add_u32 v5, s21, v5
  v_add_u32 v6, s21, v6
  v_add_u32 v7, s21, v7
  ds_read_b32 v4, v4
  ds_read_b32 v5, v5
  ds_read_b32 v6, v6
  ds_read_b32 v7, v7
  s_lshl_b32 s21, s20, 10
  s_add_u32 s21, s21, 85120
  s_mov_b32 s62, 105472
  v_lshl_add_u32 v3, v1, 2, s21
  s_waitcnt lgkmcnt(3)
  v_add_u32 v9, v14, v4
  v_and_b32 v9, 0xffff, v9
  v_lshlrev_b32 v9, 4, v9
  ds_write_b128 v9, v[40:43] offset:32768
  s_waitcnt lgkmcnt(3)
  v_add_u32 v9, v15, v5
  v_and_b32 v9, 0xffff, v9
  v_lshlrev_b32 v9, 4, v9
  ds_write_b128 v9, v[44:47] offset:32768
  s_waitcnt lgkmcnt(3)
  v_add_u32 v9, v16, v6
  v_and_b32 v9, 0xffff, v9
  v_lshlrev_b32 v9, 4, v9
  ds_write_b128 v9, v[48:51] offset:32768
  s_waitcnt lgkmcnt(3)
  v_add_u32 v9, v17, v7
  v_and_b32 v9, 0xffff, v9
  v_lshlrev_b32 v9, 4, v9
  ds_write_b128 v9, v[52:55] offset:32768
  s_mov_b64 exec, 1
  ds_add_u32 v126, v127 offset:62472
  s_mov_b64 exec, -1
L_staged:
  s_add_u32 s61, s60, 7
  v_readlane_b32 s48, v24, s60
  v_readlane_b32 s49, v29, s61
  s_mul_i32 s21, s2, 28672
  s_add_u32 s23, s21, 4096
  s_and_b32 s48, s48, 0xfff8
  s_and_b32 s49, s49, 0xffff
  s_add_u32 s49, s49, 7
  s_and_b32 s49, s49, 0xfff8
  v_add_lshl_u32 v2, s48, v1, 4
  s_sub_u32 s49, s49, s48
L_sw4:
  ds_read_b32 v9, v126 offset:62472
  s_waitcnt lgkmcnt(0)
  v_cmp_gt_u32 vcc, 7, v9
  s_cbranch_vccnz L_sw4
L_pub:
  ds_read_b128 v[40:43], v2 offset:32768
  ds_read_b128 v[44:47], v2 offset:33792
  ds_read_b128 v[48:51], v2 offset:34816
  ds_read_b128 v[52:55], v2 offset:35840
  ds_read_b128 v[56:59], v2 offset:36864
  s_cmp_le_i32 s49, 0
  s_cbranch_scc1 L_pubdone
  s_sub_u32 s48, s49, 0
  s_bfm_b64 s[50:51], s48, 0
  s_cmp_ge_u32 s48, 64
  s_cselect_b64 exec, -1, s[50:51]
  s_waitcnt lgkmcnt(4)
  buffer_store_dwordx4 v[40:43], v2, s[32:35], s21 offen offset:0 sc1
  s_cmp_le_i32 s49, 64
  s_cbranch_scc1 L_pubdone
  s_sub_u32 s48, s49, 64
  s_bfm_b64 s[50:51], s48, 0
  s_cmp_ge_u32 s48, 64
  s_cselect_b64 exec, -1, s[50:51]
  s_waitcnt lgkmcnt(3)
  buffer_store_dwordx4 v[44:47], v2, s[32:35], s21 offen offset:1024 sc1
  s_cmp_le_i32 s49, 128
  s_cbranch_scc1 L_pubdone
  s_sub_u32 s48, s49, 128
  s_bfm_b64 s[50:51], s48, 0
  s_cmp_ge_u32 s48, 64
  s_cselect_b64 exec, -1, s[50:51]
  s_waitcnt lgkmcnt(2)
  buffer_store_dwordx4 v[48:51], v2, s[32:35], s21 offen offset:2048 sc1
  s_cmp_le_i32 s49, 192
  s_cbranch_scc1 L_pubdone
  s_sub_u32 s48, s49, 192
  s_bfm_b64 s[50:51], s48, 0
  s_cmp_ge_u32 s48, 64
  s_cselect_b64 exec, -1, s[50:51]
  s_waitcnt lgkmcnt(1)
  buffer_store_dwordx4 v[52:55], v2, s[32:35], s21 offen offset:3072 sc1
  s_cmp_le_i32 s49, 256
  s_cbranch_scc1 L_pubdone
  s_sub_u32 s48, s49, 256
  s_bfm_b64 s[50:51], s48, 0
  s_cmp_ge_u32 s48, 64
  s_cselect_b64 exec, -1, s[50:51]
  s_waitcnt lgkmcnt(0)
  buffer_store_dwordx4 v[56:59], v2, s[32:35], s23 offen offset:0 sc1
  s_sub_u32 s49, s49, 320
  s_cmp_le_i32 s49, 0
  s_cbranch_scc1 L_pubdone
  v_add_u32 v2, 5120, v2
  s_waitcnt vmcnt(0)
  s_branch L_pub
L_pubdone:
  s_mov_b64 exec, -1
  s_cmp_eq_u32 s20, 7
  s_cbranch_scc1 L_nopw
  v_lshrrev_b32 v4, 16, v4
  v_lshl_add_u32 v14, v14, 2, s62
  v_lshl_add_u32 v14, v4, 6, v14
  ds_write_b32 v3, v14 offset:0
  v_lshrrev_b32 v5, 16, v5
  v_lshl_add_u32 v15, v15, 2, s62
  v_lshl_add_u32 v15, v5, 6, v15
  ds_write_b32 v3, v15 offset:256
  v_lshrrev_b32 v6, 16, v6
  v_lshl_add_u32 v16, v16, 2, s62
  v_lshl_add_u32 v16, v6, 6, v16
  ds_write_b32 v3, v16 offset:512
  v_lshrrev_b32 v7, 16, v7
  v_lshl_add_u32 v17, v17, 2, s62
  v_lshl_add_u32 v17, v7, 6, v17
  ds_write_b32 v3, v17 offset:768
L_nopw:
  s_mov_b64 exec, 1
  ds_add_u32 v126, v127 offset:62476
  s_mov_b64 exec, -1
  v_and_b32 v72, 0x7ff, v24
  v_and_b32 v9, 0x7ff, v20
  v_lshl_or_b32 v72, v9, 11, v72
  v_lshrrev_b32 v9, 16, v24
  v_lshl_or_b32 v72, v9, 22, v72
  v_mov_b32 v73, v8
  v_and_b32 v74, 0x7ff, v25
  v_and_b32 v9, 0x7ff, v21
  v_lshl_or_b32 v74, v9, 11, v74
  v_lshrrev_b32 v9, 16, v25
  v_lshl_or_b32 v74, v9, 22, v74
  v_mov_b32 v75, v8
  v_and_b32 v76, 0x7ff, v26
  v_and_b32 v9, 0x7ff, v22
  v_lshl_or_b32 v76, v9, 11, v76
  v_lshrrev_b32 v9, 16, v26
  v_lshl_or_b32 v76, v9, 22, v76
  v_mov_b32 v77, v8
  v_and_b32 v78, 0x7ff, v27
  v_and_b32 v9, 0x7ff, v23
  v_lshl_or_b32 v78, v9, 11, v78
  v_lshrrev_b32 v9, 16, v27
  v_lshl_or_b32 v78, v9, 22, v78
  v_mov_b32 v79, v8
  s_xor_b32 s61, s60, 8
  s_bfm_b64 s[50:51], 8, s61
  v_lshlrev_b32 v70, 5, v1
  v_xor_b32 v71, 256, v70
  v_add_u32 v71, 16, v71
  v_mov_b32_dpp v80, v76 row_ror:8 row_mask:0xf bank_mask:0xf
  v_mov_b32_dpp v81, v78 row_ror:8 row_mask:0xf bank_mask:0xf
  s_mov_b64 exec, s[50:51]
  v_mov_b32 v70, v71
  v_mov_b32 v72, v80
  v_mov_b32 v74, v81
  s_mov_b64 exec, -1
  s_lshl_b32 s21, s2, 11
  s_add_u32 s21, s21, 4096
  s_and_b32 s61, s60, 0x30
  s_bfm_b64 s[50:51], 16, s61
  s_lshr_b32 s22, s57, 5
  s_sub_u32 s22, s22, s20
  s_and_b32 s22, s22, 7
  v_and_b32 v2, 31, v1
  v_lshl_add_u32 v2, v2, 3, s22
  v_lshlrev_b32 v3, 11, v2
  v_mul_u32_u24 v15, 368, v2
  v_mul_u32_u24 v2, 1792, v2
  v_mov_b32 v18, 0
  v_mov_b32 v19, 0
  v_mov_b32 v37, 0
  v_mov_b32 v38, 0
  v_mov_b32 v156, 0
L_sw5:
  ds_read_b32 v9, v126 offset:62484
  s_waitcnt lgkmcnt(0)
  v_cmp_gt_u32 vcc, 1, v9
  s_cbranch_vccnz L_sw5

  s_waitcnt vmcnt(0)
  s_mov_b64 exec, s[50:51]
  buffer_store_dwordx4 v[72:75], v70, s[28:31], s21 offen sc1
  s_mov_b64 exec, -1
  s_mov_b64 exec, 1
  ds_add_u32 v126, v127 offset:62504
  s_mov_b64 exec, -1
  s_cmp_ge_u32 s57, 250
  s_cbranch_scc0 L_own
  s_sleep 100
  s_branch L_C
L_own:
  s_lshl_b32 s21, s57, 3
  s_add_u32 s21, s21, 4096
  s_mov_b32 s22, 60000
  s_mul_i32 s55, s20, 1408
  s_add_u32 s44, s55, 32768
  s_add_u32 s55, s55, 62592
  v_mov_b32 v4, 0
  v_mov_b32 v31, 0x1ff8
  s_lshl_b32 s63, s20, 12
  s_add_u32 s63, s63, 130048
  v_mov_b32 v60, 0
  v_mov_b32 v61, 0
  v_mov_b32 v62, 0
  v_mov_b32 v63, 0
  v_lshl_add_u32 v39, v1, 4, s63
  ds_write_b128 v39, v[60:63] offset:0
  ds_write_b128 v39, v[60:63] offset:1024
  ds_write_b128 v39, v[60:63] offset:2048
  ds_write_b128 v39, v[60:63] offset:3072
  v_mov_b32 v130, 0x80080000
  v_lshl_add_u32 v131, v1, 2, s55
  ds_write_b32 v131, v130 offset:0
  ds_write_b32 v131, v130 offset:256
  ds_write_b32 v131, v130 offset:512
  ds_write_b32 v131, v130 offset:768
  ds_write_b32 v131, v130 offset:1024
  v_mov_b32 v132, s55
  v_add_u32 v132, 1280, v132
  s_lshl_b32 s56, s20, 10
  s_add_u32 s56, s56, 73856
  v_mov_b32 v133, s56
  v_add_u32 v133, 512, v133
  v_mov_b32 v10, 0xfffff
  v_mov_b32 v12, 0x1000000
  v_lshrrev_b32 v134, 2, v1
  v_lshl_add_u32 v135, v134, 2, s56
  v_and_b32 v136, 3, v1
  v_lshlrev_b32 v136, 4, v136
  v_add_u32 v138, 64, v1
  v_add_u32 v139, 128, v1
  v_add_u32 v140, 192, v1
  v_add_u32 v141, 256, v1
  v_mov_b32 v137, v1
L_sw6:
  ds_read_b32 v9, v126 offset:62504
  s_waitcnt lgkmcnt(0)
  v_cmp_gt_u32 vcc, 8, v9
  s_cbranch_vccz L_sx6
  s_sleep 1
  s_branch L_sw6
L_sx6:
  s_mov_b64 exec, 0xffffffff
L_pd:
  buffer_load_dwordx2 v[4:5], v3, s[28:31], s21 offen sc1
  s_waitcnt vmcnt(0)
  v_cmpx_ne_u32 vcc, v5, v8
  s_cbranch_execz L_pdok
  s_sleep 6
  s_sub_u32 s22, s22, 1
  s_cmp_lg_u32 s22, 0
  s_cbranch_scc1 L_pd
  s_mov_b64 exec, -1
  v_mov_b32 v4, 0
  ds_write_b32 v126, v127 offset:62492
L_pdok:
  s_mov_b64 exec, -1
  v_bfe_u32 v6, v4, 11, 11
  v_add_u32 v9, 15, v6
  v_and_b32 v9, 0xfff0, v9
  v_lshl_or_b32 v7, v9, 12, v6
  v_lshrrev_b32 v5, 22, v4
  v_mov_b32 v16, v7
  v_add_u32_dpp v7, v7, v7 row_shr:1 row_mask:0xf bank_mask:0xf
  v_and_b32 v4, 0x7ff, v4
  v_add_u32 v15, v15, v5
  v_add_u32_dpp v7, v7, v7 row_shr:2 row_mask:0xf bank_mask:0xf
  v_add_u32 v4, v2, v4
  v_cmp_eq_u32 s[50:51], 0, v6
  v_add_u32_dpp v7, v7, v7 row_shr:4 row_mask:0xf bank_mask:0xf
  v_cmp_lt_u32 s[46:47], 32, v6
  v_cmp_lt_u32 vcc, 16, v6
  v_add_u32_dpp v7, v7, v7 row_shr:8 row_mask:0xf bank_mask:0xf
  s_mov_b32 s52, 0
  s_mov_b32 s62, 0
  v_add_u32_dpp v7, v7, v7 row_bcast:15 row_mask:0xa bank_mask:0xf
  s_nop 0
  v_readlane_b32 s23, v7, 31
  v_sub_u32 v7, v7, v16
  v_lshrrev_b32 v17, 16, v7
  v_and_b32 v7, 0xffff, v7
  v_sub_u32 v4, v4, v7
  s_lshr_b32 s53, s23, 16
  s_and_b32 s23, s23, 0xffff
  s_cmp_gt_u32 s23, 320
  s_cbranch_scc1 L_gen
  s_cmp_lg_u64 s[46:47], 0
  s_cbranch_scc1 L_gen
  v_lshl_add_u32 v13, v7, 2, s55
  v_lshlrev_b32 v9, 4, v17
  v_cndmask_b32 v13, v13, v132, s[50:51]
  v_sub_u32 v9, v9, v7
  v_and_b32 v4, v10, v4
  v_and_b32 v9, 0x3ff, v9
  v_lshl_or_b32 v4, v9, 20, v4
  v_lshl_add_u32 v14, v17, 2, s56
  v_lshl_add_u32 v11, s23, 2, v131
  v_cndmask_b32 v14, v14, v133, s[50:51]
  s_cbranch_vccz L_x16
  ds_write_b32 v13, v4 offset:124
  ds_write_b32 v13, v4 offset:120
  ds_write_b32 v13, v4 offset:116
  ds_write_b32 v13, v4 offset:112
  ds_write_b32 v13, v4 offset:108
  ds_write_b32 v13, v4 offset:104
  ds_write_b32 v13, v4 offset:100
  ds_write_b32 v13, v4 offset:96
  ds_write_b32 v13, v4 offset:92
  ds_write_b32 v13, v4 offset:88
  ds_write_b32 v13, v4 offset:84
  ds_write_b32 v13, v4 offset:80
  ds_write_b32 v13, v4 offset:76
  ds_write_b32 v13, v4 offset:72
  ds_write_b32 v13, v4 offset:68
  ds_write_b32 v13, v4 offset:64
  v_add_u32 v9, 1, v15
  ds_write_b32 v14, v9 offset:4
L_x16:
  ds_write_b32 v13, v4 offset:60
  ds_write_b32 v13, v4 offset:56
  ds_write_b32 v13, v4 offset:52
  ds_write_b32 v13, v4 offset:48
  ds_write_b32 v13, v4 offset:44
  ds_write_b32 v13, v4 offset:40
  ds_write_b32 v13, v4 offset:36
  ds_write_b32 v13, v4 offset:32
  ds_write_b32 v13, v4 offset:28
  ds_write_b32 v13, v4 offset:24
  ds_write_b32 v13, v4 offset:20
  ds_write_b32 v13, v4 offset:16
  ds_write_b32 v13, v4 offset:12
  ds_write_b32 v13, v4 offset:8
  ds_write_b32 v13, v4 offset:4
  ds_write_b32 v13, v4 offset:0
  s_mov_b64 exec, 0xffffffff
  ds_write_b32 v11, v130
  s_mov_b64 exec, -1
  ds_read_b32 v32, v131 offset:0
  ds_read_b32 v33, v131 offset:256
  ds_read_b32 v34, v131 offset:512
  ds_read_b32 v35, v131 offset:768
  ds_read_b32 v36, v131 offset:1024
  ds_write_b32 v14, v15
  s_mov_b32 s54, s23
  s_waitcnt lgkmcnt(5)
  v_add_u32 v11, v32, v137
  v_and_b32 v11, v10, v11
  v_lshlrev_b32 v11, 4, v11
  buffer_load_dwordx4 v[40:43], v11, s[32:35], 0 offen sc1
  s_waitcnt lgkmcnt(4)
  v_add_u32 v11, v33, v138
  v_and_b32 v11, v10, v11
  v_lshlrev_b32 v11, 4, v11
  buffer_load_dwordx4 v[44:47], v11, s[32:35], 0 offen sc1
  s_waitcnt lgkmcnt(3)
  v_add_u32 v11, v34, v139
  v_and_b32 v11, v10, v11
  v_lshlrev_b32 v11, 4, v11
  buffer_load_dwordx4 v[48:51], v11, s[32:35], 0 offen sc1
  s_waitcnt lgkmcnt(2)
  v_add_u32 v11, v35, v140
  v_and_b32 v11, v10, v11
  v_lshlrev_b32 v11, 4, v11
  buffer_load_dwordx4 v[52:55], v11, s[32:35], 0 offen sc1
  s_waitcnt lgkmcnt(1)
  v_add_u32 v11, v36, v141
  v_and_b32 v11, v10, v11
  v_lshlrev_b32 v11, 4, v11
  buffer_load_dwordx4 v[56:59], v11, s[32:35], 0 offen sc1
  v_mov_b32 v14, 0x3ff
  v_mov_b32 v30, 0xbff
  v_add_u32 v9, v7, v6
  v_cmp_ne_u32 s[46:47], 0, v6
  s_mov_b32 s96, 0
  s_mov_b32 s101, 0
  v_cmp_lt_u32 vcc, 128, v9
  s_nop 0
  s_and_b64 vcc, vcc, s[46:47]
  s_ff1_i32_b64 s48, vcc
  s_and_b32 s48, s48, 63
  v_readlane_b32 s49, v17, s48
  s_cmp_eq_u64 vcc, 0
  s_nop 1
  s_cselect_b32 s49, s53, s49
  s_add_u32 s48, s96, 16
  s_min_u32 s98, s49, s48
  s_cmp_gt_u32 s23, 128
  s_cselect_b32 s101, s98, s101
  v_cmp_lt_u32 vcc, 192, v9
  s_nop 0
  s_and_b64 vcc, vcc, s[46:47]
  s_ff1_i32_b64 s48, vcc
  s_and_b32 s48, s48, 63
  v_readlane_b32 s49, v17, s48
  s_cmp_eq_u64 vcc, 0
  s_nop 1
  s_cselect_b32 s49, s53, s49
  s_add_u32 s48, s98, 16
  s_min_u32 s99, s49, s48
  s_cmp_gt_u32 s23, 192
  s_cselect_b32 s101, s99, s101
  v_cmp_lt_u32 vcc, 256, v9
  s_nop 0
  s_and_b64 vcc, vcc, s[46:47]
  s_ff1_i32_b64 s48, vcc
  s_and_b32 s48, s48, 63
  v_readlane_b32 s49, v17, s48
  s_cmp_eq_u64 vcc, 0
  s_nop 1
  s_cselect_b32 s49, s53, s49
  s_add_u32 s48, s99, 16
  s_min_u32 s100, s49, s48
  s_cmp_gt_u32 s23, 256
  s_cselect_b32 s101, s100, s101
  s_lshl_b32 s48, s96, 2
  v_add_u32 v11, s48, v135
  ds_read_b32 v149, v11
  s_lshl_b32 s48, s96, 6
  v_add_u32 v153, s48, v39
  s_lshl_b32 s48, s98, 2
  v_add_u32 v11, s48, v135
  ds_read_b32 v150, v11
  s_lshl_b32 s48, s98, 6
  v_add_u32 v154, s48, v39
  s_lshl_b32 s48, s99, 2
  v_add_u32 v11, s48, v135
  ds_read_b32 v151, v11
  s_lshl_b32 s48, s99, 6
  v_add_u32 v155, s48, v39
  s_lshl_b32 s48, s101, 2
  v_add_u32 v11, s48, v135
  ds_read_b32 v18, v11 offset:0
  ds_read_b32 v19, v11 offset:64
  ds_read_b32 v37, v11 offset:128
  ds_read_b32 v38, v11 offset:192
  s_lshl_b32 s48, s101, 6
  v_add_u32 v156, s48, v39
  v_lshrrev_b32 v32, 20, v32
  v_add_u32 v32, v32, v137
  v_and_b32 v32, v30, v32
  v_min_u32 v32, v14, v32
  v_lshl_add_u32 v32, v32, 2, s63
  v_lshrrev_b32 v33, 20, v33
  v_add_u32 v33, v33, v138
  v_and_b32 v33, v30, v33
  v_min_u32 v33, v14, v33
  v_lshl_add_u32 v33, v33, 2, s63
  v_lshrrev_b32 v34, 20, v34
  v_add_u32 v34, v34, v139
  v_and_b32 v34, v30, v34
  v_min_u32 v34, v14, v34
  v_lshl_add_u32 v34, v34, 2, s63
  v_lshrrev_b32 v35, 20, v35
  v_add_u32 v35, v35, v140
  v_and_b32 v35, v30, v35
  v_min_u32 v35, v14, v35
  v_lshl_add_u32 v35, v35, 2, s63
  v_lshrrev_b32 v36, 20, v36
  v_add_u32 v36, v36, v141
  v_and_b32 v36, v30, v36
  v_min_u32 v36, v14, v36
  v_lshl_add_u32 v36, v36, 2, s63
  s_waitcnt lgkmcnt(0)
  s_sub_u32 s48, s98, s96
  v_cmp_gt_u32 vcc, s48, v134
  v_lshl_add_u32 v149, v149, 6, v136
  s_nop 0
  v_cndmask_b32 v149, v12, v149, vcc
  s_sub_u32 s48, s99, s98
  v_cmp_gt_u32 vcc, s48, v134
  v_lshl_add_u32 v150, v150, 6, v136
  s_nop 0
  v_cndmask_b32 v150, v12, v150, vcc
  s_sub_u32 s48, s100, s99
  v_cmp_gt_u32 vcc, s48, v134
  v_lshl_add_u32 v151, v151, 6, v136
  s_nop 0
  v_cndmask_b32 v151, v12, v151, vcc
  s_sub_u32 s53, s53, s101
  v_cmp_gt_u32 vcc, s53, v134
  v_lshl_add_u32 v18, v18, 6, v136
  v_add_u32 v134, 16, v134
  v_cndmask_b32 v18, v12, v18, vcc
  v_cmp_gt_u32 vcc, s53, v134
  v_lshl_add_u32 v19, v19, 6, v136
  v_add_u32 v134, 16, v134
  v_cndmask_b32 v19, v12, v19, vcc
  v_cmp_gt_u32 vcc, s53, v134
  v_lshl_add_u32 v37, v37, 6, v136
  v_add_u32 v134, 16, v134
  v_cndmask_b32 v37, v12, v37, vcc
  v_cmp_gt_u32 vcc, s53, v134
  v_lshl_add_u32 v38, v38, 6, v136
  v_add_u32 v134, 16, v134
  v_cndmask_b32 v38, v12, v38, vcc
  s_branch L_prepd
L_gen:
  s_mov_b64 exec, 1
  ds_add_u32 v126, v127 offset:62500
  s_mov_b64 exec, -1
  s_mov_b32 s62, 1
  v_mov_b32 v148, 0x10000000
  v_mov_b32 v152, v39
  v_mov_b32 v149, 0x10000000
  v_mov_b32 v153, v39
  v_mov_b32 v150, 0x10000000
  v_mov_b32 v154, v39
  v_mov_b32 v151, 0x10000000
  v_mov_b32 v155, v39
  v_lshlrev_b32 v15, 4, v15
  v_sub_u32 v17, v15, v7
  v_lshrrev_b32 v9, 12, v16
  v_mov_b32 v12, v6
L_pad:
  v_cmpx_lt_u32 vcc, v12, v9
  s_cbranch_execz L_paddone
  v_add_lshl_u32 v13, v15, v12, 2
  buffer_store_dword v126, v13, s[36:39], 0 offen sc1
  v_add_u32 v12, 1, v12
  s_branch L_pad
L_paddone:
  s_mov_b64 exec, -1
  s_waitcnt vmcnt(0)
L_sw7:
  ds_read_b32 v9, v126 offset:62476
  s_waitcnt lgkmcnt(0)
  v_cmp_gt_u32 vcc, 8, v9
  s_cbranch_vccz L_sx7
  s_sleep 1
  s_branch L_sw7
L_sx7:
L_xgen:
  v_mov_b32 v9, 0
  v_subrev_u32 v12, s52, v7
  v_mov_b32 v14, 320
L_exp:
  v_cmpx_lt_u32 vcc, v9, v6
  s_cbranch_execz L_expdone
  v_lshl_add_u32 v13, v12, 2, s55
  v_lshl_add_u32 v11, v12, 2, s44
  v_cmpx_lt_u32 vcc, v12, v14
  ds_write_b32 v13, v4
  ds_write_b32 v11, v17
  s_mov_b64 exec, -1
  v_add_u32 v9, 1, v9
  v_add_u32 v12, 1, v12
  s_branch L_exp
L_expdone:
  s_mov_b64 exec, -1
  v_mov_b32 v12, 0x1000000
  v_lshl_add_u32 v13, v1, 2, s55
  ds_read_b32 v32, v13 offset:0
  ds_read_b32 v33, v13 offset:256
  ds_read_b32 v34, v13 offset:512
  ds_read_b32 v35, v13 offset:768
  ds_read_b32 v36, v13 offset:1024
  v_add_u32 v9, s52, v1
  s_sub_u32 s54, s23, s52
  v_cmp_gt_u32 vcc, s23, v9
  s_waitcnt lgkmcnt(4)
  v_add_u32 v11, v32, v9
  v_and_b32 v11, v10, v11
  v_cndmask_b32 v11, v12, v11, vcc
  v_lshlrev_b32 v11, 4, v11
  buffer_load_dwordx4 v[40:43], v11, s[32:35], 0 offen sc1
  v_add_u32 v9, 64, v9
  v_cmp_gt_u32 vcc, s23, v9
  s_waitcnt lgkmcnt(3)
  v_add_u32 v11, v33, v9
  v_and_b32 v11, v10, v11
  v_cndmask_b32 v11, v12, v11, vcc
  v_lshlrev_b32 v11, 4, v11
  buffer_load_dwordx4 v[44:47], v11, s[32:35], 0 offen sc1
  v_add_u32 v9, 64, v9
  v_cmp_gt_u32 vcc, s23, v9
  s_waitcnt lgkmcnt(2)
  v_add_u32 v11, v34, v9
  v_and_b32 v11, v10, v11
  v_cndmask_b32 v11, v12, v11, vcc
  v_lshlrev_b32 v11, 4, v11
  buffer_load_dwordx4 v[48:51], v11, s[32:35], 0 offen sc1
  v_add_u32 v9, 64, v9
  v_cmp_gt_u32 vcc, s23, v9
  s_waitcnt lgkmcnt(1)
  v_add_u32 v11, v35, v9
  v_and_b32 v11, v10, v11
  v_cndmask_b32 v11, v12, v11, vcc
  v_lshlrev_b32 v11, 4, v11
  buffer_load_dwordx4 v[52:55], v11, s[32:35], 0 offen sc1
  v_add_u32 v9, 64, v9
  v_cmp_gt_u32 vcc, s23, v9
  s_waitcnt lgkmcnt(0)
  v_add_u32 v11, v36, v9
  v_and_b32 v11, v10, v11
  v_cndmask_b32 v11, v12, v11, vcc
  v_lshlrev_b32 v11, 4, v11
  buffer_load_dwordx4 v[56:59], v11, s[32:35], 0 offen sc1
  v_add_u32 v9, 64, v9
  v_lshl_add_u32 v13, v1, 2, s44
  v_add_u32 v9, s52, v1
  ds_read_b32 v32, v13 offset:0
  ds_read_b32 v33, v13 offset:256
  ds_read_b32 v34, v13 offset:512
  ds_read_b32 v35, v13 offset:768
  ds_read_b32 v36, v13 offset:1024
  v_cmp_gt_u32 vcc, s23, v9
  s_waitcnt lgkmcnt(4)
  v_add_u32 v32, v32, v9
  v_add_u32 v9, 64, v9
  v_cndmask_b32 v32, v12, v32, vcc
  v_lshlrev_b32 v32, 2, v32
  v_cmp_gt_u32 vcc, s23, v9
  s_waitcnt lgkmcnt(3)
  v_add_u32 v33, v33, v9
  v_add_u32 v9, 64, v9
  v_cndmask_b32 v33, v12, v33, vcc
  v_lshlrev_b32 v33, 2, v33
  v_cmp_gt_u32 vcc, s23, v9
  s_waitcnt lgkmcnt(2)
  v_add_u32 v34, v34, v9
  v_add_u32 v9, 64, v9
  v_cndmask_b32 v34, v12, v34, vcc
  v_lshlrev_b32 v34, 2, v34
  v_cmp_gt_u32 vcc, s23, v9
  s_waitcnt lgkmcnt(1)
  v_add_u32 v35, v35, v9
  v_add_u32 v9, 64, v9
  v_cndmask_b32 v35, v12, v35, vcc
  v_lshlrev_b32 v35, 2, v35
  v_cmp_gt_u32 vcc, s23, v9
  s_waitcnt lgkmcnt(0)
  v_add_u32 v36, v36, v9
  v_add_u32 v9, 64, v9
  v_cndmask_b32 v36, v12, v36, vcc
  v_lshlrev_b32 v36, 2, v36
L_prepd:
  s_cmp_lg_u32 s52, 0
  s_cbranch_scc1 L_nob4
L_sw8:
  ds_read_b32 v9, v126 offset:62480
  s_waitcnt lgkmcnt(0)
  v_cmp_gt_u32 vcc, 8, v9
  s_cbranch_vccz L_sx8
  s_sleep 2
  s_branch L_sw8
L_sx8:
L_nob4:
  s_mov_b32 s47, 0
  s_cmp_le_i32 s54, 0
  s_cbranch_scc1 L_stepsdone
  s_waitcnt vmcnt(4)
  v_and_b32 v30, 6, v40
  v_lshlrev_b32 v30, 12, v30
  v_and_or_b32 v60, v40, v31, v30
  ds_read_b64 v[72:73], v60
  v_alignbit_b32 v61, v40, v40, 10
  v_alignbit_b32 v62, v40, v40, 20
  v_and_or_b32 v61, v61, v31, v30
  v_and_or_b32 v62, v62, v31, v30
  ds_read_b64 v[74:75], v61
  ds_read_b64 v[76:77], v62
  v_and_or_b32 v63, v41, v31, v30
  ds_read_b64 v[78:79], v63
  v_alignbit_b32 v64, v41, v41, 10
  v_alignbit_b32 v65, v41, v41, 20
  v_and_or_b32 v64, v64, v31, v30
  v_and_or_b32 v65, v65, v31, v30
  ds_read_b64 v[80:81], v64
  ds_read_b64 v[82:83], v65
  v_and_or_b32 v66, v42, v31, v30
  ds_read_b64 v[84:85], v66
  v_alignbit_b32 v67, v42, v42, 10
  v_alignbit_b32 v68, v42, v42, 20
  v_and_or_b32 v67, v67, v31, v30
  v_and_or_b32 v68, v68, v31, v30
  ds_read_b64 v[86:87], v67
  ds_read_b64 v[88:89], v68
  v_and_or_b32 v69, v43, v31, v30
  ds_read_b64 v[90:91], v69
  v_alignbit_b32 v70, v43, v43, 10
  v_alignbit_b32 v71, v43, v43, 20
  v_and_or_b32 v70, v70, v31, v30
  v_and_or_b32 v71, v71, v31, v30
  ds_read_b64 v[92:93], v70
  ds_read_b64 v[94:95], v71
  s_waitcnt lgkmcnt(10)
  v_pk_add_f32 v[72:73], v[72:73], v[74:75]
  s_waitcnt lgkmcnt(9)
  v_pk_add_f32 v[72:73], v[72:73], v[76:77]
  s_waitcnt lgkmcnt(8)
  v_pk_add_f32 v[72:73], v[72:73], v[78:79]
  s_waitcnt lgkmcnt(7)
  v_pk_add_f32 v[72:73], v[72:73], v[80:81]
  s_waitcnt lgkmcnt(6)
  v_pk_add_f32 v[72:73], v[72:73], v[82:83]
  s_waitcnt lgkmcnt(5)
  v_pk_add_f32 v[72:73], v[72:73], v[84:85]
  s_waitcnt lgkmcnt(4)
  v_pk_add_f32 v[72:73], v[72:73], v[86:87]
  s_waitcnt lgkmcnt(3)
  v_pk_add_f32 v[72:73], v[72:73], v[88:89]
  s_waitcnt lgkmcnt(2)
  v_pk_add_f32 v[72:73], v[72:73], v[90:91]
  s_waitcnt lgkmcnt(1)
  v_pk_add_f32 v[72:73], v[72:73], v[92:93]
  s_waitcnt lgkmcnt(0)
  v_pk_add_f32 v[72:73], v[72:73], v[94:95]
  v_cvt_pk_bf16_f32 v72, v72, v73
  v_min_u32 v72, -2, v72
  s_cmp_eq_u32 s62, 0
  s_cbranch_scc1 L_fs0
  buffer_store_dword v72, v32, s[36:39], 0 offen sc1
  s_waitcnt vmcnt(0)
  s_branch L_fe0
L_fs0:
  ds_write_b32 v32, v72
L_fe0:
  s_cmp_le_i32 s54, 64
  s_cbranch_scc1 L_stepsdone
  s_waitcnt vmcnt(3)
  v_and_b32 v30, 6, v44
  v_lshlrev_b32 v30, 12, v30
  v_and_or_b32 v60, v44, v31, v30
  ds_read_b64 v[72:73], v60
  v_alignbit_b32 v61, v44, v44, 10
  v_alignbit_b32 v62, v44, v44, 20
  v_and_or_b32 v61, v61, v31, v30
  v_and_or_b32 v62, v62, v31, v30
  ds_read_b64 v[74:75], v61
  ds_read_b64 v[76:77], v62
  v_and_or_b32 v63, v45, v31, v30
  ds_read_b64 v[78:79], v63
  v_alignbit_b32 v64, v45, v45, 10
  v_alignbit_b32 v65, v45, v45, 20
  v_and_or_b32 v64, v64, v31, v30
  v_and_or_b32 v65, v65, v31, v30
  ds_read_b64 v[80:81], v64
  ds_read_b64 v[82:83], v65
  v_and_or_b32 v66, v46, v31, v30
  ds_read_b64 v[84:85], v66
  v_alignbit_b32 v67, v46, v46, 10
  v_alignbit_b32 v68, v46, v46, 20
  v_and_or_b32 v67, v67, v31, v30
  v_and_or_b32 v68, v68, v31, v30
  ds_read_b64 v[86:87], v67
  ds_read_b64 v[88:89], v68
  v_and_or_b32 v69, v47, v31, v30
  ds_read_b64 v[90:91], v69
  v_alignbit_b32 v70, v47, v47, 10
  v_alignbit_b32 v71, v47, v47, 20
  v_and_or_b32 v70, v70, v31, v30
  v_and_or_b32 v71, v71, v31, v30
  ds_read_b64 v[92:93], v70
  ds_read_b64 v[94:95], v71
  s_waitcnt lgkmcnt(10)
  v_pk_add_f32 v[72:73], v[72:73], v[74:75]
  s_waitcnt lgkmcnt(9)
  v_pk_add_f32 v[72:73], v[72:73], v[76:77]
  s_waitcnt lgkmcnt(8)
  v_pk_add_f32 v[72:73], v[72:73], v[78:79]
  s_waitcnt lgkmcnt(7)
  v_pk_add_f32 v[72:73], v[72:73], v[80:81]
  s_waitcnt lgkmcnt(6)
  v_pk_add_f32 v[72:73], v[72:73], v[82:83]
  s_waitcnt lgkmcnt(5)
  v_pk_add_f32 v[72:73], v[72:73], v[84:85]
  s_waitcnt lgkmcnt(4)
  v_pk_add_f32 v[72:73], v[72:73], v[86:87]
  s_waitcnt lgkmcnt(3)
  v_pk_add_f32 v[72:73], v[72:73], v[88:89]
  s_waitcnt lgkmcnt(2)
  v_pk_add_f32 v[72:73], v[72:73], v[90:91]
  s_waitcnt lgkmcnt(1)
  v_pk_add_f32 v[72:73], v[72:73], v[92:93]
  s_waitcnt lgkmcnt(0)
  v_pk_add_f32 v[72:73], v[72:73], v[94:95]
  v_cvt_pk_bf16_f32 v72, v72, v73
  v_min_u32 v72, -2, v72
  s_cmp_eq_u32 s62, 0
  s_cbranch_scc1 L_fs1
  buffer_store_dword v72, v33, s[36:39], 0 offen sc1
  s_waitcnt vmcnt(0)
  s_branch L_fe1
L_fs1:
  ds_write_b32 v33, v72
L_fe1:
  ds_read_b128 v[144:147], v153
  s_cmp_le_i32 s54, 128
  s_cbranch_scc1 L_stepsdone
  s_waitcnt vmcnt(2)
  v_and_b32 v30, 6, v48
  v_lshlrev_b32 v30, 12, v30
  v_and_or_b32 v60, v48, v31, v30
  ds_read_b64 v[72:73], v60
  v_alignbit_b32 v61, v48, v48, 10
  v_alignbit_b32 v62, v48, v48, 20
  v_and_or_b32 v61, v61, v31, v30
  v_and_or_b32 v62, v62, v31, v30
  ds_read_b64 v[74:75], v61
  ds_read_b64 v[76:77], v62
  v_and_or_b32 v63, v49, v31, v30
  ds_read_b64 v[78:79], v63
  v_alignbit_b32 v64, v49, v49, 10
  v_alignbit_b32 v65, v49, v49, 20
  v_and_or_b32 v64, v64, v31, v30
  v_and_or_b32 v65, v65, v31, v30
  ds_read_b64 v[80:81], v64
  ds_read_b64 v[82:83], v65
  v_and_or_b32 v66, v50, v31, v30
  ds_read_b64 v[84:85], v66
  v_alignbit_b32 v67, v50, v50, 10
  v_alignbit_b32 v68, v50, v50, 20
  v_and_or_b32 v67, v67, v31, v30
  v_and_or_b32 v68, v68, v31, v30
  ds_read_b64 v[86:87], v67
  ds_read_b64 v[88:89], v68
  v_and_or_b32 v69, v51, v31, v30
  ds_read_b64 v[90:91], v69
  v_alignbit_b32 v70, v51, v51, 10
  v_alignbit_b32 v71, v51, v51, 20
  v_and_or_b32 v70, v70, v31, v30
  v_and_or_b32 v71, v71, v31, v30
  ds_read_b64 v[92:93], v70
  ds_read_b64 v[94:95], v71
  s_waitcnt lgkmcnt(10)
  v_pk_add_f32 v[72:73], v[72:73], v[74:75]
  buffer_store_dwordx4 v[144:147], v149, s[36:39], 0 offen sc1
  s_waitcnt lgkmcnt(9)
  v_pk_add_f32 v[72:73], v[72:73], v[76:77]
  s_waitcnt lgkmcnt(8)
  v_pk_add_f32 v[72:73], v[72:73], v[78:79]
  s_waitcnt lgkmcnt(7)
  v_pk_add_f32 v[72:73], v[72:73], v[80:81]
  s_waitcnt lgkmcnt(6)
  v_pk_add_f32 v[72:73], v[72:73], v[82:83]
  s_waitcnt lgkmcnt(5)
  v_pk_add_f32 v[72:73], v[72:73], v[84:85]
  s_waitcnt lgkmcnt(4)
  v_pk_add_f32 v[72:73], v[72:73], v[86:87]
  s_waitcnt lgkmcnt(3)
  v_pk_add_f32 v[72:73], v[72:73], v[88:89]
  s_waitcnt lgkmcnt(2)
  v_pk_add_f32 v[72:73], v[72:73], v[90:91]
  s_waitcnt lgkmcnt(1)
  v_pk_add_f32 v[72:73], v[72:73], v[92:93]
  s_waitcnt lgkmcnt(0)
  v_pk_add_f32 v[72:73], v[72:73], v[94:95]
  v_cvt_pk_bf16_f32 v72, v72, v73
  v_min_u32 v72, -2, v72
  s_cmp_eq_u32 s62, 0
  s_cbranch_scc1 L_fs2
  buffer_store_dword v72, v34, s[36:39], 0 offen sc1
  s_waitcnt vmcnt(0)
  s_branch L_fe2
L_fs2:
  ds_write_b32 v34, v72
L_fe2:
  ds_read_b128 v[144:147], v154
  s_cmp_le_i32 s54, 192
  s_cbranch_scc1 L_stepsdone
  s_waitcnt vmcnt(2)
  v_and_b32 v30, 6, v52
  v_lshlrev_b32 v30, 12, v30
  v_and_or_b32 v60, v52, v31, v30
  ds_read_b64 v[72:73], v60
  v_alignbit_b32 v61, v52, v52, 10
  v_alignbit_b32 v62, v52, v52, 20
  v_and_or_b32 v61, v61, v31, v30
  v_and_or_b32 v62, v62, v31, v30
  ds_read_b64 v[74:75], v61
  ds_read_b64 v[76:77], v62
  v_and_or_b32 v63, v53, v31, v30
  ds_read_b64 v[78:79], v63
  v_alignbit_b32 v64, v53, v53, 10
  v_alignbit_b32 v65, v53, v53, 20
  v_and_or_b32 v64, v64, v31, v30
  v_and_or_b32 v65, v65, v31, v30
  ds_read_b64 v[80:81], v64
  ds_read_b64 v[82:83], v65
  v_and_or_b32 v66, v54, v31, v30
  ds_read_b64 v[84:85], v66
  v_alignbit_b32 v67, v54, v54, 10
  v_alignbit_b32 v68, v54, v54, 20
  v_and_or_b32 v67, v67, v31, v30
  v_and_or_b32 v68, v68, v31, v30
  ds_read_b64 v[86:87], v67
  ds_read_b64 v[88:89], v68
  v_and_or_b32 v69, v55, v31, v30
  ds_read_b64 v[90:91], v69
  v_alignbit_b32 v70, v55, v55, 10
  v_alignbit_b32 v71, v55, v55, 20
  v_and_or_b32 v70, v70, v31, v30
  v_and_or_b32 v71, v71, v31, v30
  ds_read_b64 v[92:93], v70
  ds_read_b64 v[94:95], v71
  s_waitcnt lgkmcnt(10)
  v_pk_add_f32 v[72:73], v[72:73], v[74:75]
  buffer_store_dwordx4 v[144:147], v150, s[36:39], 0 offen sc1
  s_waitcnt lgkmcnt(9)
  v_pk_add_f32 v[72:73], v[72:73], v[76:77]
  s_waitcnt lgkmcnt(8)
  v_pk_add_f32 v[72:73], v[72:73], v[78:79]
  s_waitcnt lgkmcnt(7)
  v_pk_add_f32 v[72:73], v[72:73], v[80:81]
  s_waitcnt lgkmcnt(6)
  v_pk_add_f32 v[72:73], v[72:73], v[82:83]
  s_waitcnt lgkmcnt(5)
  v_pk_add_f32 v[72:73], v[72:73], v[84:85]
  s_waitcnt lgkmcnt(4)
  v_pk_add_f32 v[72:73], v[72:73], v[86:87]
  s_waitcnt lgkmcnt(3)
  v_pk_add_f32 v[72:73], v[72:73], v[88:89]
  s_waitcnt lgkmcnt(2)
  v_pk_add_f32 v[72:73], v[72:73], v[90:91]
  s_waitcnt lgkmcnt(1)
  v_pk_add_f32 v[72:73], v[72:73], v[92:93]
  s_waitcnt lgkmcnt(0)
  v_pk_add_f32 v[72:73], v[72:73], v[94:95]
  v_cvt_pk_bf16_f32 v72, v72, v73
  v_min_u32 v72, -2, v72
  s_cmp_eq_u32 s62, 0
  s_cbranch_scc1 L_fs3
  buffer_store_dword v72, v35, s[36:39], 0 offen sc1
  s_waitcnt vmcnt(0)
  s_branch L_fe3
L_fs3:
  ds_write_b32 v35, v72
L_fe3:
  ds_read_b128 v[144:147], v155
  s_cmp_le_i32 s54, 256
  s_cbranch_scc1 L_stepsdone
  s_waitcnt vmcnt(2)
  v_and_b32 v30, 6, v56
  v_lshlrev_b32 v30, 12, v30
  v_and_or_b32 v60, v56, v31, v30
  ds_read_b64 v[72:73], v60
  v_alignbit_b32 v61, v56, v56, 10
  v_alignbit_b32 v62, v56, v56, 20
  v_and_or_b32 v61, v61, v31, v30
  v_and_or_b32 v62, v62, v31, v30
  ds_read_b64 v[74:75], v61
  ds_read_b64 v[76:77], v62
  v_and_or_b32 v63, v57, v31, v30
  ds_read_b64 v[78:79], v63
  v_alignbit_b32 v64, v57, v57, 10
  v_alignbit_b32 v65, v57, v57, 20
  v_and_or_b32 v64, v64, v31, v30
  v_and_or_b32 v65, v65, v31, v30
  ds_read_b64 v[80:81], v64
  ds_read_b64 v[82:83], v65
  v_and_or_b32 v66, v58, v31, v30
  ds_read_b64 v[84:85], v66
  v_alignbit_b32 v67, v58, v58, 10
  v_alignbit_b32 v68, v58, v58, 20
  v_and_or_b32 v67, v67, v31, v30
  v_and_or_b32 v68, v68, v31, v30
  ds_read_b64 v[86:87], v67
  ds_read_b64 v[88:89], v68
  v_and_or_b32 v69, v59, v31, v30
  ds_read_b64 v[90:91], v69
  v_alignbit_b32 v70, v59, v59, 10
  v_alignbit_b32 v71, v59, v59, 20
  v_and_or_b32 v70, v70, v31, v30
  v_and_or_b32 v71, v71, v31, v30
  ds_read_b64 v[92:93], v70
  ds_read_b64 v[94:95], v71
  s_waitcnt lgkmcnt(10)
  v_pk_add_f32 v[72:73], v[72:73], v[74:75]
  buffer_store_dwordx4 v[144:147], v151, s[36:39], 0 offen sc1
  s_waitcnt lgkmcnt(9)
  v_pk_add_f32 v[72:73], v[72:73], v[76:77]
  s_waitcnt lgkmcnt(8)
  v_pk_add_f32 v[72:73], v[72:73], v[78:79]
  s_waitcnt lgkmcnt(7)
  v_pk_add_f32 v[72:73], v[72:73], v[80:81]
  s_waitcnt lgkmcnt(6)
  v_pk_add_f32 v[72:73], v[72:73], v[82:83]
  s_waitcnt lgkmcnt(5)
  v_pk_add_f32 v[72:73], v[72:73], v[84:85]
  s_waitcnt lgkmcnt(4)
  v_pk_add_f32 v[72:73], v[72:73], v[86:87]
  s_waitcnt lgkmcnt(3)
  v_pk_add_f32 v[72:73], v[72:73], v[88:89]
  s_waitcnt lgkmcnt(2)
  v_pk_add_f32 v[72:73], v[72:73], v[90:91]
  s_waitcnt lgkmcnt(1)
  v_pk_add_f32 v[72:73], v[72:73], v[92:93]
  s_waitcnt lgkmcnt(0)
  v_pk_add_f32 v[72:73], v[72:73], v[94:95]
  v_cvt_pk_bf16_f32 v72, v72, v73
  v_min_u32 v72, -2, v72
  s_cmp_eq_u32 s62, 0
  s_cbranch_scc1 L_fs4
  buffer_store_dword v72, v36, s[36:39], 0 offen sc1
  s_waitcnt vmcnt(0)
  s_branch L_fe4
L_fs4:
  ds_write_b32 v36, v72
L_fe4:
L_stepsdone:
  s_cmp_eq_u32 s62, 0
  s_cbranch_scc1 L_flush
  s_add_u32 s52, s52, 320
  s_cmp_lt_u32 s52, s23
  s_cbranch_scc0 L_C
  s_waitcnt vmcnt(0)
  s_branch L_xgen
L_flush:
  ds_read_b128 v[72:75], v156 offset:0
  s_waitcnt lgkmcnt(0)
  buffer_store_dwordx4 v[72:75], v18, s[36:39], 0 offen sc1
  s_cmp_le_u32 s53, 16
  s_cbranch_scc1 L_C
  ds_read_b128 v[76:79], v156 offset:1024
  s_waitcnt lgkmcnt(0)
  buffer_store_dwordx4 v[76:79], v19, s[36:39], 0 offen sc1
  s_cmp_le_u32 s53, 32
  s_cbranch_scc1 L_C
  ds_read_b128 v[80:83], v156 offset:2048
  s_waitcnt lgkmcnt(0)
  buffer_store_dwordx4 v[80:83], v37, s[36:39], 0 offen sc1
  s_cmp_le_u32 s53, 48
  s_cbranch_scc1 L_C
  ds_read_b128 v[84:87], v156 offset:3072
  s_waitcnt lgkmcnt(0)
  buffer_store_dwordx4 v[84:87], v38, s[36:39], 0 offen sc1
L_C:
  s_mov_b64 exec, 1
  ds_add_u32 v126, v127 offset:62496
  s_mov_b64 exec, -1
  s_cmp_eq_u32 s20, 0
  s_cbranch_scc0 L_nopos
L_sw9:
  ds_read_b32 v9, v126 offset:62476
  s_waitcnt lgkmcnt(0)
  v_cmp_gt_u32 vcc, 8, v9
  s_cbranch_vccz L_sx9
  s_sleep 1
  s_branch L_sw9
L_sx9:
  v_lshlrev_b32 v9, 2, v1
  v_add_u32 v9, 85120, v9
  ds_read_b32 v96, v9 offset:0
  ds_read_b32 v97, v9 offset:256
  ds_read_b32 v98, v9 offset:512
  ds_read_b32 v99, v9 offset:768
  ds_read_b32 v100, v9 offset:1024
  ds_read_b32 v101, v9 offset:1280
  ds_read_b32 v102, v9 offset:1536
  ds_read_b32 v103, v9 offset:1792
  ds_read_b32 v104, v9 offset:2048
  ds_read_b32 v105, v9 offset:2304
  ds_read_b32 v106, v9 offset:2560
  ds_read_b32 v107, v9 offset:2816
  s_waitcnt lgkmcnt(0)
  ds_read_b32 v108, v9 offset:3072
  ds_read_b32 v109, v9 offset:3328
  ds_read_b32 v110, v9 offset:3584
  ds_read_b32 v111, v9 offset:3840
  ds_read_b32 v112, v9 offset:4096
  ds_read_b32 v113, v9 offset:4352
  ds_read_b32 v114, v9 offset:4608
  ds_read_b32 v115, v9 offset:4864
  ds_read_b32 v116, v9 offset:5120
  ds_read_b32 v117, v9 offset:5376
  ds_read_b32 v118, v9 offset:5632
  ds_read_b32 v119, v9 offset:5888
  s_waitcnt lgkmcnt(0)
  ds_read_b32 v120, v9 offset:6144
  ds_read_b32 v121, v9 offset:6400
  ds_read_b32 v122, v9 offset:6656
  ds_read_b32 v123, v9 offset:6912
L_nopos:
  v_readlane_b32 s48, v24, s60
  s_mul_i32 s21, s2, 23552
  s_mov_b32 s22, 60000
  v_mov_b32 v12, 0x10000000
  s_lshr_b32 s48, s48, 16
  s_lshl_b32 s48, s48, 6
  s_add_u32 s61, s60, 7
  v_readlane_b32 s49, v29, s61
  v_lshl_add_u32 v3, v1, 4, s48
  s_nop 1
  s_lshr_b32 s49, s49, 16
  s_lshl_b32 s49, s49, 6
L_sw10:
  ds_read_b32 v9, v126 offset:62496
  s_waitcnt lgkmcnt(0)
  v_cmp_gt_u32 vcc, 8, v9
  s_cbranch_vccz L_sx10
  s_sleep 1
  s_branch L_sw10
L_sx10:
L_rwin:
  v_add_u32 v2, 1024, v3
  v_cmp_gt_u32 vcc, s49, v3
  v_cmp_gt_u32 s[50:51], s49, v2
  s_nop 0
  v_cndmask_b32 v5, v12, v3, vcc
  v_cndmask_b32 v6, v12, v2, s[50:51]
  s_waitcnt vmcnt(0)
  buffer_load_dwordx4 v[40:43], v5, s[36:39], s21 offen sc1
  buffer_load_dwordx4 v[44:47], v6, s[36:39], s21 offen sc1
L_pr:
  s_waitcnt vmcnt(0)
  v_max3_u32 v2, v40, v41, v42
  v_max3_u32 v4, v44, v45, v46
  v_max_u32 v2, v2, v43
  v_max_u32 v4, v4, v47
  v_cmp_eq_u32 s[52:53], -1, v2
  v_cmp_eq_u32 s[54:55], -1, v4
  s_nop 1
  s_or_b64 s[62:63], s[52:53], s[54:55]
  s_cbranch_scc0 L_prok

  s_mov_b64 exec, s[52:53]
  s_cbranch_execz L_pr1
  buffer_load_dwordx4 v[40:43], v5, s[36:39], s21 offen sc1
L_pr1:
  s_mov_b64 exec, s[54:55]
  s_cbranch_execz L_pr2
  buffer_load_dwordx4 v[44:47], v6, s[36:39], s21 offen sc1
L_pr2:
  s_mov_b64 exec, -1
  s_sub_u32 s22, s22, 1
  s_cmp_lg_u32 s22, 0
  s_cbranch_scc1 L_pr
  s_waitcnt vmcnt(0)
  s_mov_b32 s22, 1
  ds_write_b32 v126, v127 offset:62492
L_prok:
  s_mov_b64 exec, vcc
  v_add_u32 v2, 105472, v3
  ds_write_b128 v2, v[40:43]
  s_mov_b64 exec, s[50:51]
  ds_write_b128 v2, v[44:47] offset:1024
  s_mov_b64 exec, -1
  s_add_u32 s48, s48, 2048
  v_add_u32 v3, 2048, v3
  s_cmp_lt_u32 s48, s49
  s_cbranch_scc1 L_rwin
  s_waitcnt lgkmcnt(0)
  s_barrier
  s_cmp_eq_u32 s20, 0
  s_cbranch_scc1 L_fin
  s_endpgm
L_fin:
  ds_read_b32 v4, v126 offset:62492
  ds_read_b32 v44, v96
  ds_read_b32 v45, v97
  ds_read_b32 v46, v98
  ds_read_b32 v47, v99
  ds_read_b32 v48, v100
  ds_read_b32 v49, v101
  ds_read_b32 v50, v102
  ds_read_b32 v51, v103
  ds_read_b32 v52, v104
  ds_read_b32 v53, v105
  ds_read_b32 v54, v106
  ds_read_b32 v55, v107
  ds_read_b32 v56, v108
  ds_read_b32 v57, v109
  s_lshl_b32 s21, s2, 7
  v_lshlrev_b32 v3, 1, v1
  s_mov_b32 s22, 0x1f800000
  s_mov_b32 s23, 0x5f800000
  v_mov_b32 v5, 0x3f80
  v_mov_b32 v6, 0x3f800000
  v_mov_b32 v40, 0
  v_mov_b32 v41, 0
  s_waitcnt lgkmcnt(13)
  ds_read_b32 v58, v110
  v_dot2_f32_bf16 v40, v44, v5, v40
  v_dot2_f32_bf16 v41, v44, v6, v41
  s_waitcnt lgkmcnt(13)
  ds_read_b32 v59, v111
  v_dot2_f32_bf16 v40, v45, v5, v40
  v_dot2_f32_bf16 v41, v45, v6, v41
  s_waitcnt lgkmcnt(13)
  ds_read_b32 v60, v112
  v_dot2_f32_bf16 v40, v46, v5, v40
  v_dot2_f32_bf16 v41, v46, v6, v41
  s_waitcnt lgkmcnt(13)
  ds_read_b32 v61, v113
  v_dot2_f32_bf16 v40, v47, v5, v40
  v_dot2_f32_bf16 v41, v47, v6, v41
  s_waitcnt lgkmcnt(13)
  ds_read_b32 v62, v114
  v_dot2_f32_bf16 v40, v48, v5, v40
  v_dot2_f32_bf16 v41, v48, v6, v41
  s_waitcnt lgkmcnt(13)
  ds_read_b32 v63, v115
  v_dot2_f32_bf16 v40, v49, v5, v40
  v_dot2_f32_bf16 v41, v49, v6, v41
  s_waitcnt lgkmcnt(13)
  ds_read_b32 v64, v116
  v_dot2_f32_bf16 v40, v50, v5, v40
  v_dot2_f32_bf16 v41, v50, v6, v41
  s_waitcnt lgkmcnt(13)
  ds_read_b32 v65, v117
  v_dot2_f32_bf16 v40, v51, v5, v40
  v_dot2_f32_bf16 v41, v51, v6, v41
  s_waitcnt lgkmcnt(13)
  ds_read_b32 v66, v118
  v_dot2_f32_bf16 v40, v52, v5, v40
  v_dot2_f32_bf16 v41, v52, v6, v41
  s_waitcnt lgkmcnt(13)
  ds_read_b32 v67, v119
  v_dot2_f32_bf16 v40, v53, v5, v40
  v_dot2_f32_bf16 v41, v53, v6, v41
  s_waitcnt lgkmcnt(13)
  ds_read_b32 v68, v120
  v_dot2_f32_bf16 v40, v54, v5, v40
  v_dot2_f32_bf16 v41, v54, v6, v41
  s_waitcnt lgkmcnt(13)
  ds_read_b32 v69, v121
  v_dot2_f32_bf16 v40, v55, v5, v40
  v_dot2_f32_bf16 v41, v55, v6, v41
  s_waitcnt lgkmcnt(13)
  ds_read_b32 v70, v122
  v_dot2_f32_bf16 v40, v56, v5, v40
  v_dot2_f32_bf16 v41, v56, v6, v41
  s_waitcnt lgkmcnt(13)
  ds_read_b32 v71, v123
  v_dot2_f32_bf16 v40, v57, v5, v40
  v_dot2_f32_bf16 v41, v57, v6, v41
  s_waitcnt lgkmcnt(13)
  v_dot2_f32_bf16 v40, v58, v5, v40
  v_dot2_f32_bf16 v41, v58, v6, v41
  s_waitcnt lgkmcnt(12)
  v_dot2_f32_bf16 v40, v59, v5, v40
  v_dot2_f32_bf16 v41, v59, v6, v41
  s_waitcnt lgkmcnt(11)
  v_dot2_f32_bf16 v40, v60, v5, v40
  v_dot2_f32_bf16 v41, v60, v6, v41
  s_waitcnt lgkmcnt(10)
  v_dot2_f32_bf16 v40, v61, v5, v40
  v_dot2_f32_bf16 v41, v61, v6, v41
  s_waitcnt lgkmcnt(9)
  v_dot2_f32_bf16 v40, v62, v5, v40
  v_dot2_f32_bf16 v41, v62, v6, v41
  s_waitcnt lgkmcnt(8)
  v_dot2_f32_bf16 v40, v63, v5, v40
  v_dot2_f32_bf16 v41, v63, v6, v41
  s_waitcnt lgkmcnt(7)
  v_dot2_f32_bf16 v40, v64, v5, v40
  v_dot2_f32_bf16 v41, v64, v6, v41
  s_waitcnt lgkmcnt(6)
  v_dot2_f32_bf16 v40, v65, v5, v40
  v_dot2_f32_bf16 v41, v65, v6, v41
  s_waitcnt lgkmcnt(5)
  v_dot2_f32_bf16 v40, v66, v5, v40
  v_dot2_f32_bf16 v41, v66, v6, v41
  s_waitcnt lgkmcnt(4)
  v_dot2_f32_bf16 v40, v67, v5, v40
  v_dot2_f32_bf16 v41, v67, v6, v41
  s_waitcnt lgkmcnt(3)
  v_dot2_f32_bf16 v40, v68, v5, v40
  v_dot2_f32_bf16 v41, v68, v6, v41
  s_waitcnt lgkmcnt(2)
  v_dot2_f32_bf16 v40, v69, v5, v40
  v_dot2_f32_bf16 v41, v69, v6, v41
  s_waitcnt lgkmcnt(1)
  v_dot2_f32_bf16 v40, v70, v5, v40
  v_dot2_f32_bf16 v41, v70, v6, v41
  s_waitcnt lgkmcnt(0)
  v_dot2_f32_bf16 v40, v71, v5, v40
  v_dot2_f32_bf16 v41, v71, v6, v41
  s_nop 2
  v_rcp_f32 v42, v40
  v_cmp_le_f32 s[50:51], s22, v40
  v_cmp_ge_f32 s[52:53], s23, v40
  v_cmp_ge_f32 vcc, s23, |v41|
  v_mul_f32 v42, v42, v41
  s_and_b64 s[50:51], s[50:51], s[52:53]
  s_and_b64 s[50:51], s[50:51], vcc
  v_cvt_pk_bf16_f32 v42, v42, v42
  buffer_store_short v42, v3, s[40:43], s21 offen sc1
  v_cmp_ne_u32 vcc, 0, v4
  s_mov_b64 exec, 1
  s_cbranch_vccz L_notmo
  buffer_atomic_umax v8, v126, s[28:31], 0 offen sc1
  s_branch L_noep
L_notmo:
  s_cmp_eq_u32 s2, 0
  s_cbranch_scc0 L_noep
  buffer_store_dword v8, v126, s[28:31], 0 offen sc1
L_noep:
  s_mov_b64 exec, -1
  s_not_b64 s[50:51], s[50:51]
  s_cbranch_scc1 L_slow
  s_endpgm
L_T:
  s_cmp_ge_u32 s57, 250
  s_cbranch_scc0 L_Tgo
  s_barrier
  s_endpgm
L_Tgo:
  s_sub_u32 s21, s20, 8

  v_lshrrev_b32 v2, 5, v1
  v_and_b32 v3, 31, v1
  v_lshlrev_b32 v0, 4, v2
  v_lshl_add_u32 v19, v3, 6, v0
  v_lshlrev_b32 v4, 4, v1
  v_lshlrev_b32 v5, 2, v1
  s_barrier
  s_waitcnt lgkmcnt(0)
  s_mov_b32 s24, s6
  s_and_b32 s25, s7, 0xffff
  s_mov_b32 s26, 64000
  s_mov_b32 s27, 0x00020000
  s_cmp_eq_u32 s21, 0
  s_cbranch_scc0 L_Tp1
  s_mov_b32 s28, s8
  s_and_b32 s29, s9, 0xffff
  s_mov_b32 s30, 2048
  s_mov_b32 s31, 0x00020000
  s_mov_b32 m0, 82048
  s_nop 0
  buffer_load_dwordx4 v4, s[28:31], 0 offen lds
  buffer_load_dwordx4 v4, s[28:31], 0 offen offset:1024 lds
  s_branch L_Tnopar
L_Tp1:
  s_cmp_eq_u32 s21, 1
  s_cbranch_scc0 L_Tp2
  s_mov_b32 s28, s10
  s_and_b32 s29, s11, 0xffff
  s_mov_b32 s30, 64
  s_mov_b32 s31, 0x00020000
  s_mov_b32 m0, 84096
  s_nop 0
  buffer_load_dword v5, s[28:31], 0 offen lds
  s_mov_b32 m0, 84864
  s_lshl_b32 s22, s57, 8
  buffer_load_dword v5, s[24:27], s22 offen lds
  s_branch L_Tnopar
L_Tp2:
  s_cmp_eq_u32 s21, 2
  s_cbranch_scc0 L_Tp3
  s_mov_b32 s28, s12
  s_and_b32 s29, s13, 0xffff
  s_mov_b32 s30, 64
  s_mov_b32 s31, 0x00020000
  s_mov_b32 m0, 84352
  s_and_b32 s22, s58, 7
  buffer_load_dword v5, s[28:31], 0 offen lds
  s_lshl_b32 s22, s22, 13
  v_lshlrev_b32 v5, 7, v1
  buffer_load_dword v53, v5, s[24:27], s22 offen
  s_branch L_Tnopar
L_Tp3:
  s_mov_b32 s28, s14
  s_and_b32 s29, s15, 0xffff
  s_mov_b32 s30, 64
  s_mov_b32 s31, 0x00020000
  s_mov_b32 m0, 84608
  s_nop 0
  buffer_load_dword v5, s[28:31], 0 offen lds
L_Tnopar:
  s_lshl_b32 s49, s21, 14
  buffer_load_dwordx4 v[104:107], v19, s[24:27], s49 offen offset:0
  buffer_load_dwordx4 v[108:111], v19, s[24:27], s49 offen offset:32
  buffer_load_dwordx4 v[112:115], v19, s[24:27], s49 offen offset:2048
  buffer_load_dwordx4 v[116:119], v19, s[24:27], s49 offen offset:2080
  s_add_u32 s49, s49, 4096
  buffer_load_dwordx4 v[120:123], v19, s[24:27], s49 offen offset:0
  buffer_load_dwordx4 v[124:127], v19, s[24:27], s49 offen offset:32
  buffer_load_dwordx4 v[128:131], v19, s[24:27], s49 offen offset:2048
  buffer_load_dwordx4 v[132:135], v19, s[24:27], s49 offen offset:2080
  s_add_u32 s49, s49, 4096
  buffer_load_dwordx4 v[136:139], v19, s[24:27], s49 offen offset:0
  buffer_load_dwordx4 v[140:143], v19, s[24:27], s49 offen offset:32
  buffer_load_dwordx4 v[144:147], v19, s[24:27], s49 offen offset:2048
  buffer_load_dwordx4 v[148:151], v19, s[24:27], s49 offen offset:2080
  s_add_u32 s49, s49, 4096
  buffer_load_dwordx4 v[152:155], v19, s[24:27], s49 offen offset:0
  buffer_load_dwordx4 v[156:159], v19, s[24:27], s49 offen offset:32
  buffer_load_dwordx4 v[160:163], v19, s[24:27], s49 offen offset:2048
  buffer_load_dwordx4 v[164:167], v19, s[24:27], s49 offen offset:2080
  v_mov_b32 v57, 0
  v_mov_b32 v59, 0
  v_mov_b32 v61, 0
  v_mov_b32 v63, 0
  v_mov_b32 v65, 0
  v_mov_b32 v67, 0
  v_mov_b32 v69, 0
  v_mov_b32 v71, 0
  v_mov_b32 v44, 0
  v_mov_b32 v45, 0
  v_mov_b32 v46, 0
  v_mov_b32 v47, 0
  v_mov_b32 v48, 0
  v_mov_b32 v49, 0
  v_mov_b32 v50, 0
  v_mov_b32 v51, 0
  v_mov_b32 v0, 0x3f80
  s_mov_b32 s40, 0x10100101
  s_mov_b32 s41, 0x10100101
  v_cndmask_b32 v11, 0, -1, s[40:41]
  s_mov_b32 s42, 0x40400404
  s_mov_b32 s43, 0x0
  v_cndmask_b32 v48, 0, v0, s[42:43]
  s_mov_b32 s32, 0x30003
  s_mov_b32 s33, 0x30003
  s_mov_b32 s34, 0x300030
  s_mov_b32 s35, 0x300030
  s_mov_b32 s36, 0x3000300
  s_mov_b32 s37, 0x3000300
  s_mov_b32 s38, 0x30003000
  s_mov_b32 s39, 0x30003000
  v_and_b32 v0, 1, v1
  v_lshlrev_b32 v54, 2, v0
  v_bfe_u32 v4, v1, 4, 1
  v_lshl_add_u32 v54, v4, 3, v54
  v_lshl_add_u32 v54, v2, 5, v54
  v_add_u32 v54, 84352, v54
  v_mul_u32_u24 v0, 0xaaaa, v0
  v_add_u32 v52, 0x4444, v0
  v_mov_b32 v0, 82048
  v_lshl_add_u32 v12, v2, 9, v0
  v_lshl_add_u32 v12, v3, 1, v12
  v_and_b32 v13, 0x13, v3
  v_and_b32 v4, 4, v3
  v_lshl_or_b32 v13, v4, 1, v13
  v_and_b32 v4, 8, v3
  v_lshrrev_b32 v4, 1, v4
  v_or_b32 v13, v13, v4
  v_lshl_add_u32 v55, v13, 1, v0
  v_lshlrev_b32 v13, 6, v13
  v_lshl_add_u32 v14, v2, 4, v0
  v_add_u32 v13, v13, v14
  v_lshl_add_u32 v15, v2, 3, v0
  s_lshl_b32 s48, s21, 6
  s_add_u32 s48, s48, 84864
  v_lshl_add_u32 v16, v2, 4, s48
  s_lshr_b32 s48, s21, 1
  s_lshl_b32 s48, s48, 7
  s_and_b32 s23, s21, 1
  s_lshl_b32 s22, s23, 5
  s_add_u32 s48, s48, s22
  s_add_u32 s48, s48, 84864
  v_bfe_u32 v4, v1, 3, 1
  v_lshlrev_b32 v4, 6, v4
  v_lshl_add_u32 v4, v2, 4, v4
  v_add_u32 v17, s48, v4
  v_lshlrev_b32 v18, 4, v1
  v_add_u32 v18, 93184, v18
  v_cmp_le_u32 s[50:51], 8, v3
  v_lshlrev_b32 v0, 13, v2
  v_lshl_add_u32 v0, v3, 3, v0
  s_lshl_b32 s48, s21, 11
  v_add_u32 v0, s48, v0
  s_lshl_b32 s44, s21, 11
  s_lshl_b32 s45, s21, 10
  s_add_u32 s45, s45, 8192
  v_add_u32 v2, s44, v18
  v_add_u32 v3, s45, v18
  v_mov_b32 v4, 0
  v_mov_b32 v5, 1
  s_mov_b32 s46, 0x3f38aa3b
  s_waitcnt vmcnt(16)
  s_mov_b64 exec, 1
  ds_add_u32 v4, v5 offset:62480
  s_mov_b64 exec, -1
L_sw11:
  ds_read_b32 v6, v4 offset:62480
  s_waitcnt lgkmcnt(0)
  v_cmp_gt_u32 vcc, 4, v6
  s_cbranch_vccz L_sx11
  s_sleep 1
  s_branch L_sw11
L_sx11:
  ds_read_b128 v[36:39], v14 offset:2304
  ds_read_b128 v[88:91], v13 offset:0
  ds_read_b128 v[40:43], v14 offset:2336
  ds_read_b128 v[92:95], v13 offset:32
  ds_read_u16 v44, v55 offset:2560
  ds_read_b128 v[20:23], v16 offset:0
  ds_read_b128 v[24:27], v16 offset:32
  ds_read_u16 v56, v12 offset:0
  ds_read_u16_d16_hi v57, v12 offset:64
  ds_read_u16 v58, v12 offset:128
  ds_read_u16_d16_hi v59, v12 offset:192
  ds_read_u16 v60, v12 offset:256
  ds_read_u16_d16_hi v61, v12 offset:320
  ds_read_u16 v62, v12 offset:384
  ds_read_u16_d16_hi v63, v12 offset:448
  s_waitcnt lgkmcnt(12)
  v_and_b32 v36, v11, v36
  v_and_b32 v37, v11, v37
  v_and_b32 v38, v11, v38
  v_and_b32 v39, v11, v39
  v_and_b32 v40, v11, v40
  v_and_b32 v41, v11, v41
  v_and_b32 v42, v11, v42
  v_and_b32 v43, v11, v43
  s_waitcnt lgkmcnt(6)
  ds_read_u16 v64, v12 offset:1024
  ds_read_u16_d16_hi v65, v12 offset:1088
  ds_read_u16 v66, v12 offset:1152
  ds_read_u16_d16_hi v67, v12 offset:1216
  ds_read_u16 v68, v12 offset:1280
  ds_read_u16_d16_hi v69, v12 offset:1344
  ds_read_u16 v70, v12 offset:1408
  ds_read_u16_d16_hi v71, v12 offset:1472
  v_mfma_f32_32x32x16_bf16 v[72:87], v[88:91], v[36:39], 0
  v_mfma_f32_32x32x16_bf16 v[72:87], v[92:95], v[40:43], v[72:87]
  v_mfma_f32_32x32x16_bf16 v[72:87], v[44:47], v[48:51], v[72:87]
  s_waitcnt lgkmcnt(8)
  ds_read_b128 v[28:31], v17
  ds_read2_b32 v[32:33], v54 offset0:0 offset1:4
  ds_read_b64 v[96:97], v15 offset:2048
  ds_read_b64 v[98:99], v15 offset:2064
  ds_read_b64 v[100:101], v15 offset:2080
  ds_read_b64 v[102:103], v15 offset:2096
  v_dot2_f32_bf16 v4, v20, v56, 0
  v_dot2_f32_bf16 v5, v20, v57, 0
  v_dot2_f32_bf16 v6, v21, v58, 0
  v_dot2_f32_bf16 v7, v21, v59, 0
  v_dot2_f32_bf16 v8, v22, v60, 0
  v_dot2_f32_bf16 v9, v22, v61, 0
  v_dot2_f32_bf16 v10, v23, v62, 0
  v_dot2_f32_bf16 v11, v23, v63, 0
  v_cvt_pk_bf16_f32 v20, v4, v5
  v_cvt_pk_bf16_f32 v21, v6, v7
  v_cvt_pk_bf16_f32 v22, v8, v9
  v_cvt_pk_bf16_f32 v23, v10, v11
  ds_write_b128 v2, v[20:23]
  s_waitcnt lgkmcnt(7)
  v_dot2_f32_bf16 v4, v24, v64, 0
  v_dot2_f32_bf16 v5, v24, v65, 0
  v_dot2_f32_bf16 v6, v25, v66, 0
  v_dot2_f32_bf16 v7, v25, v67, 0
  v_dot2_f32_bf16 v8, v26, v68, 0
  v_dot2_f32_bf16 v9, v26, v69, 0
  v_dot2_f32_bf16 v10, v27, v70, 0
  v_dot2_f32_bf16 v11, v27, v71, 0
  v_cvt_pk_bf16_f32 v24, v4, v5
  v_cvt_pk_bf16_f32 v25, v6, v7
  v_cvt_pk_bf16_f32 v26, v8, v9
  v_cvt_pk_bf16_f32 v27, v10, v11
  ds_write_b128 v2, v[24:27] offset:1024
  v_mov_b32 v55, 0xffff0000
  s_cmp_eq_u32 s23, 0
  s_cbranch_scc1 L_Tk0
  v_mov_b32 v72, v80
  v_mov_b32 v73, v81
  v_mov_b32 v74, v82
  v_mov_b32 v75, v83
  v_mov_b32 v76, v84
  v_mov_b32 v77, v85
  v_mov_b32 v78, v86
  v_mov_b32 v79, v87
L_Tk0:
  s_waitcnt lgkmcnt(7)
  v_lshlrev_b32 v4, 16, v28
  v_and_b32 v5, v55, v28
  v_mul_f32 v4, v4, v72
  v_mul_f32 v5, v5, v73
  v_cvt_pk_bf16_f32 v36, v4, v5
  v_lshlrev_b32 v4, 16, v29
  v_and_b32 v5, v55, v29
  v_mul_f32 v4, v4, v74
  v_mul_f32 v5, v5, v75
  v_cvt_pk_bf16_f32 v37, v4, v5
  v_lshlrev_b32 v4, 16, v30
  v_and_b32 v5, v55, v30
  v_mul_f32 v4, v4, v76
  v_mul_f32 v5, v5, v77
  v_cvt_pk_bf16_f32 v38, v4, v5
  v_lshlrev_b32 v4, 16, v31
  v_and_b32 v5, v55, v31
  v_mul_f32 v4, v4, v78
  v_mul_f32 v5, v5, v79
  v_cvt_pk_bf16_f32 v39, v4, v5
  ds_write_b128 v3, v[36:39]
  v_mov_b32 v2, 0
  v_mov_b32 v3, 1
  v_mov_b32 v53, v18
  s_mov_b64 exec, 1
  ds_add_u32 v2, v3 offset:62488
  s_mov_b64 exec, -1
  s_waitcnt lgkmcnt(3)
  v_lshlrev_b32 v4, 16, v96
  v_and_b32 v5, v55, v96
  v_lshlrev_b32 v6, 16, v97
  v_and_b32 v7, v55, v97
  v_lshlrev_b32 v8, 16, v98
  v_and_b32 v9, v55, v98
  v_lshlrev_b32 v10, 16, v99
  v_and_b32 v11, v55, v99
  v_lshlrev_b32 v12, 16, v100
  v_and_b32 v13, v55, v100
  v_lshlrev_b32 v14, 16, v101
  v_and_b32 v15, v55, v101
  v_lshlrev_b32 v16, 16, v102
  v_and_b32 v17, v55, v102
  v_lshlrev_b32 v18, 16, v103
  v_and_b32 v19, v55, v103
  v_lshlrev_b32 v54, 16, v32
  v_and_b32 v3, v55, v32
  v_cvt_pk_f16_f32 v72, v54, v3
  v_lshlrev_b32 v54, 16, v33
  v_and_b32 v3, v55, v33
  v_cvt_pk_f16_f32 v73, v54, v3
  v_cvt_pk_f16_f32 v88, |v4|, |v5|
  v_cvt_pk_f16_f32 v89, |v6|, |v7|
  v_cvt_pk_f16_f32 v90, |v8|, |v9|
  v_cvt_pk_f16_f32 v91, |v10|, |v11|
  v_cvt_pk_f16_f32 v92, |v12|, |v13|
  v_cvt_pk_f16_f32 v93, |v14|, |v15|
  v_cvt_pk_f16_f32 v94, |v16|, |v17|
  v_cvt_pk_f16_f32 v95, |v18|, |v19|
  v_cndmask_b32 v44, 0, v72, s[32:33]
  v_cndmask_b32 v45, 0, v73, s[32:33]
  v_cndmask_b32 v46, 0, v72, s[34:35]
  v_cndmask_b32 v47, 0, v73, s[34:35]
  v_cndmask_b32 v48, 0, v72, s[36:37]
  v_cndmask_b32 v49, 0, v73, s[36:37]
  v_cndmask_b32 v50, 0, v72, s[38:39]
  v_cndmask_b32 v51, 0, v73, s[38:39]
  v_mov_b32 v96, 0
  v_mov_b32 v97, 0
  v_mov_b32 v98, 0
  v_mov_b32 v99, 0
  s_nop 1
  v_smfmac_f32_16x16x64_f16 v[96:99], v[44:47], v[88:95], v52
  v_smfmac_f32_16x16x64_f16 v[96:99], v[48:51], v[88:95], v52
L_sw12:
  ds_read_b32 v3, v2 offset:62488
  s_waitcnt lgkmcnt(0)
  v_cmp_gt_u32 vcc, 4, v3
  s_cbranch_vccnz L_sw12
  ds_read_b128 v[20:23], v53 offset:0
  ds_read_b128 v[24:27], v53 offset:1024
  ds_read_b128 v[36:39], v53 offset:8192
  ds_read_b128 v[40:43], v53 offset:9216
  ds_read_b128 v[28:31], v53 offset:2048
  ds_read_b128 v[32:35], v53 offset:3072
  s_nop 1
  v_add_f32 v1, v96, v97
  v_mul_f32 v1, s46, v1
  v_sub_f32 v1, 0, v1
  s_setprio 3
  s_waitcnt vmcnt(14) lgkmcnt(2)
  v_mfma_f32_32x32x16_bf16 v[56:71], v[20:23], v[104:107], v[4:19]
  v_mfma_f32_16x16x32_bf16 v[96:99], v[36:39], v[104:107], 0
  v_mfma_f32_32x32x16_bf16 v[56:71], v[24:27], v[108:111], v[56:71]
  s_nop 9
  s_waitcnt lgkmcnt(0)
  v_mfma_f32_32x32x16_bf16 v[72:87], v[28:31], v[104:107], v[4:19]
  v_cvt_pk_f16_f32 v88, |v56|, |v57|
  v_cvt_pk_f16_f32 v89, |v58|, |v59|
  v_cvt_pk_f16_f32 v90, |v60|, |v61|
  v_mfma_f32_32x32x16_bf16 v[72:87], v[32:35], v[108:111], v[72:87]
  v_cvt_pk_f16_f32 v91, |v62|, |v63|
  v_cvt_pk_f16_f32 v92, |v64|, |v65|
  v_cvt_pk_f16_f32 v93, |v66|, |v67|
  v_cvt_pk_f16_f32 v94, |v68|, |v69|
  v_cvt_pk_f16_f32 v95, |v70|, |v71|
  v_mfma_f32_16x16x32_bf16 v[96:99], v[40:43], v[108:111], v[96:99]
  s_nop 1
  v_smfmac_f32_16x16x64_f16 v[96:99], v[44:47], v[88:95], v52
  s_nop 0
  s_waitcnt vmcnt(12)
  v_mfma_f32_32x32x16_bf16 v[56:71], v[20:23], v[112:115], v[4:19]
  v_cvt_pk_f16_f32 v88, |v72|, |v73|
  v_cvt_pk_f16_f32 v89, |v74|, |v75|
  v_cvt_pk_f16_f32 v90, |v76|, |v77|
  v_mfma_f32_32x32x16_bf16 v[56:71], v[24:27], v[116:119], v[56:71]
  v_cvt_pk_f16_f32 v91, |v78|, |v79|
  v_cvt_pk_f16_f32 v92, |v80|, |v81|
  v_cvt_pk_f16_f32 v93, |v82|, |v83|
  v_cvt_pk_f16_f32 v94, |v84|, |v85|
  v_cvt_pk_f16_f32 v95, |v86|, |v87|
  s_nop 1
  v_smfmac_f32_16x16x64_f16 v[96:99], v[48:51], v[88:95], v52
  v_mfma_f32_16x16x32_bf16 v[100:103], v[36:39], v[112:115], 0
  s_nop 1
  v_mfma_f32_32x32x16_bf16 v[72:87], v[28:31], v[112:115], v[4:19]
  v_cvt_pk_f16_f32 v88, |v56|, |v57|
  v_cvt_pk_f16_f32 v89, |v58|, |v59|
  v_cvt_pk_f16_f32 v90, |v60|, |v61|
  v_mfma_f32_32x32x16_bf16 v[72:87], v[32:35], v[116:119], v[72:87]
  v_cvt_pk_f16_f32 v91, |v62|, |v63|
  v_cvt_pk_f16_f32 v92, |v64|, |v65|
  v_cvt_pk_f16_f32 v93, |v66|, |v67|
  v_cvt_pk_f16_f32 v94, |v68|, |v69|
  v_cvt_pk_f16_f32 v95, |v70|, |v71|
  v_mfma_f32_16x16x32_bf16 v[100:103], v[40:43], v[116:119], v[100:103]
  v_add_f32 v2, v96, v97
  v_fma_f32 v2, v2, s46, v1
  v_smfmac_f32_16x16x64_f16 v[100:103], v[44:47], v[88:95], v52
  v_exp_f32 v2, v2
  s_waitcnt vmcnt(10)
  v_mfma_f32_32x32x16_bf16 v[56:71], v[20:23], v[120:123], v[4:19]
  v_cvt_pk_f16_f32 v88, |v72|, |v73|
  v_cvt_pk_f16_f32 v89, |v74|, |v75|
  v_cvt_pk_f16_f32 v90, |v76|, |v77|
  v_mfma_f32_32x32x16_bf16 v[56:71], v[24:27], v[124:127], v[56:71]
  v_cvt_pk_f16_f32 v91, |v78|, |v79|
  v_cvt_pk_f16_f32 v92, |v80|, |v81|
  v_cvt_pk_f16_f32 v93, |v82|, |v83|
  v_cvt_pk_f16_f32 v94, |v84|, |v85|
  v_cvt_pk_f16_f32 v95, |v86|, |v87|
  v_mul_f32 v3, v2, v98
  ds_write_b64 v0, v[2:3] offset:0
  v_smfmac_f32_16x16x64_f16 v[100:103], v[48:51], v[88:95], v52
  v_mfma_f32_16x16x32_bf16 v[96:99], v[36:39], v[120:123], 0
  s_nop 1
  v_mfma_f32_32x32x16_bf16 v[72:87], v[28:31], v[120:123], v[4:19]
  v_cvt_pk_f16_f32 v88, |v56|, |v57|
  v_cvt_pk_f16_f32 v89, |v58|, |v59|
  v_cvt_pk_f16_f32 v90, |v60|, |v61|
  v_mfma_f32_32x32x16_bf16 v[72:87], v[32:35], v[124:127], v[72:87]
  v_cvt_pk_f16_f32 v91, |v62|, |v63|
  v_cvt_pk_f16_f32 v92, |v64|, |v65|
  v_cvt_pk_f16_f32 v93, |v66|, |v67|
  v_cvt_pk_f16_f32 v94, |v68|, |v69|
  v_cvt_pk_f16_f32 v95, |v70|, |v71|
  v_mfma_f32_16x16x32_bf16 v[96:99], v[40:43], v[124:127], v[96:99]
  v_add_f32 v2, v100, v101
  v_fma_f32 v2, v2, s46, v1
  v_smfmac_f32_16x16x64_f16 v[96:99], v[44:47], v[88:95], v52
  v_exp_f32 v2, v2
  s_waitcnt vmcnt(8)
  v_mfma_f32_32x32x16_bf16 v[56:71], v[20:23], v[128:131], v[4:19]
  v_cvt_pk_f16_f32 v88, |v72|, |v73|
  v_cvt_pk_f16_f32 v89, |v74|, |v75|
  v_cvt_pk_f16_f32 v90, |v76|, |v77|
  v_mfma_f32_32x32x16_bf16 v[56:71], v[24:27], v[132:135], v[56:71]
  v_cvt_pk_f16_f32 v91, |v78|, |v79|
  v_cvt_pk_f16_f32 v92, |v80|, |v81|
  v_cvt_pk_f16_f32 v93, |v82|, |v83|
  v_cvt_pk_f16_f32 v94, |v84|, |v85|
  v_cvt_pk_f16_f32 v95, |v86|, |v87|
  v_mul_f32 v3, v2, v102
  ds_write_b64 v0, v[2:3] offset:256
  v_smfmac_f32_16x16x64_f16 v[96:99], v[48:51], v[88:95], v52
  v_mfma_f32_16x16x32_bf16 v[100:103], v[36:39], v[128:131], 0
  s_nop 1
  v_mfma_f32_32x32x16_bf16 v[72:87], v[28:31], v[128:131], v[4:19]
  v_cvt_pk_f16_f32 v88, |v56|, |v57|
  v_cvt_pk_f16_f32 v89, |v58|, |v59|
  v_cvt_pk_f16_f32 v90, |v60|, |v61|
  v_mfma_f32_32x32x16_bf16 v[72:87], v[32:35], v[132:135], v[72:87]
  v_cvt_pk_f16_f32 v91, |v62|, |v63|
  v_cvt_pk_f16_f32 v92, |v64|, |v65|
  v_cvt_pk_f16_f32 v93, |v66|, |v67|
  v_cvt_pk_f16_f32 v94, |v68|, |v69|
  v_cvt_pk_f16_f32 v95, |v70|, |v71|
  v_mfma_f32_16x16x32_bf16 v[100:103], v[40:43], v[132:135], v[100:103]
  v_add_f32 v2, v96, v97
  v_fma_f32 v2, v2, s46, v1
  v_smfmac_f32_16x16x64_f16 v[100:103], v[44:47], v[88:95], v52
  v_exp_f32 v2, v2
  s_waitcnt vmcnt(6)
  v_mfma_f32_32x32x16_bf16 v[56:71], v[20:23], v[136:139], v[4:19]
  v_cvt_pk_f16_f32 v88, |v72|, |v73|
  v_cvt_pk_f16_f32 v89, |v74|, |v75|
  v_cvt_pk_f16_f32 v90, |v76|, |v77|
  v_mfma_f32_32x32x16_bf16 v[56:71], v[24:27], v[140:143], v[56:71]
  v_cvt_pk_f16_f32 v91, |v78|, |v79|
  v_cvt_pk_f16_f32 v92, |v80|, |v81|
  v_cvt_pk_f16_f32 v93, |v82|, |v83|
  v_cvt_pk_f16_f32 v94, |v84|, |v85|
  v_cvt_pk_f16_f32 v95, |v86|, |v87|
  v_mul_f32 v3, v2, v98
  ds_write_b64 v0, v[2:3] offset:512
  v_smfmac_f32_16x16x64_f16 v[100:103], v[48:51], v[88:95], v52
  v_mfma_f32_16x16x32_bf16 v[96:99], v[36:39], v[136:139], 0
  s_nop 1
  v_mfma_f32_32x32x16_bf16 v[72:87], v[28:31], v[136:139], v[4:19]
  v_cvt_pk_f16_f32 v88, |v56|, |v57|
  v_cvt_pk_f16_f32 v89, |v58|, |v59|
  v_cvt_pk_f16_f32 v90, |v60|, |v61|
  v_mfma_f32_32x32x16_bf16 v[72:87], v[32:35], v[140:143], v[72:87]
  v_cvt_pk_f16_f32 v91, |v62|, |v63|
  v_cvt_pk_f16_f32 v92, |v64|, |v65|
  v_cvt_pk_f16_f32 v93, |v66|, |v67|
  v_cvt_pk_f16_f32 v94, |v68|, |v69|
  v_cvt_pk_f16_f32 v95, |v70|, |v71|
  v_mfma_f32_16x16x32_bf16 v[96:99], v[40:43], v[140:143], v[96:99]
  v_add_f32 v2, v100, v101
  v_fma_f32 v2, v2, s46, v1
  v_smfmac_f32_16x16x64_f16 v[96:99], v[44:47], v[88:95], v52
  v_exp_f32 v2, v2
  s_waitcnt vmcnt(4)
  v_mfma_f32_32x32x16_bf16 v[56:71], v[20:23], v[144:147], v[4:19]
  v_cvt_pk_f16_f32 v88, |v72|, |v73|
  v_cvt_pk_f16_f32 v89, |v74|, |v75|
  v_cvt_pk_f16_f32 v90, |v76|, |v77|
  v_mfma_f32_32x32x16_bf16 v[56:71], v[24:27], v[148:151], v[56:71]
  v_cvt_pk_f16_f32 v91, |v78|, |v79|
  v_cvt_pk_f16_f32 v92, |v80|, |v81|
  v_cvt_pk_f16_f32 v93, |v82|, |v83|
  v_cvt_pk_f16_f32 v94, |v84|, |v85|
  v_cvt_pk_f16_f32 v95, |v86|, |v87|
  v_mul_f32 v3, v2, v102
  ds_write_b64 v0, v[2:3] offset:768
  v_smfmac_f32_16x16x64_f16 v[96:99], v[48:51], v[88:95], v52
  v_mfma_f32_16x16x32_bf16 v[100:103], v[36:39], v[144:147], 0
  s_nop 1
  v_mfma_f32_32x32x16_bf16 v[72:87], v[28:31], v[144:147], v[4:19]
  v_cvt_pk_f16_f32 v88, |v56|, |v57|
  v_cvt_pk_f16_f32 v89, |v58|, |v59|
  v_cvt_pk_f16_f32 v90, |v60|, |v61|
  v_mfma_f32_32x32x16_bf16 v[72:87], v[32:35], v[148:151], v[72:87]
  v_cvt_pk_f16_f32 v91, |v62|, |v63|
  v_cvt_pk_f16_f32 v92, |v64|, |v65|
  v_cvt_pk_f16_f32 v93, |v66|, |v67|
  v_cvt_pk_f16_f32 v94, |v68|, |v69|
  v_cvt_pk_f16_f32 v95, |v70|, |v71|
  v_mfma_f32_16x16x32_bf16 v[100:103], v[40:43], v[148:151], v[100:103]
  v_add_f32 v2, v96, v97
  v_fma_f32 v2, v2, s46, v1
  v_smfmac_f32_16x16x64_f16 v[100:103], v[44:47], v[88:95], v52
  v_exp_f32 v2, v2
  s_waitcnt vmcnt(2)
  v_mfma_f32_32x32x16_bf16 v[56:71], v[20:23], v[152:155], v[4:19]
  v_cvt_pk_f16_f32 v88, |v72|, |v73|
  v_cvt_pk_f16_f32 v89, |v74|, |v75|
  v_cvt_pk_f16_f32 v90, |v76|, |v77|
  v_mfma_f32_32x32x16_bf16 v[56:71], v[24:27], v[156:159], v[56:71]
  v_cvt_pk_f16_f32 v91, |v78|, |v79|
  v_cvt_pk_f16_f32 v92, |v80|, |v81|
  v_cvt_pk_f16_f32 v93, |v82|, |v83|
  v_cvt_pk_f16_f32 v94, |v84|, |v85|
  v_cvt_pk_f16_f32 v95, |v86|, |v87|
  v_mul_f32 v3, v2, v98
  ds_write_b64 v0, v[2:3] offset:1024
  v_smfmac_f32_16x16x64_f16 v[100:103], v[48:51], v[88:95], v52
  v_mfma_f32_16x16x32_bf16 v[96:99], v[36:39], v[152:155], 0
  s_nop 1
  v_mfma_f32_32x32x16_bf16 v[72:87], v[28:31], v[152:155], v[4:19]
  v_cvt_pk_f16_f32 v88, |v56|, |v57|
  v_cvt_pk_f16_f32 v89, |v58|, |v59|
  v_cvt_pk_f16_f32 v90, |v60|, |v61|
  v_mfma_f32_32x32x16_bf16 v[72:87], v[32:35], v[156:159], v[72:87]
  v_cvt_pk_f16_f32 v91, |v62|, |v63|
  v_cvt_pk_f16_f32 v92, |v64|, |v65|
  v_cvt_pk_f16_f32 v93, |v66|, |v67|
  v_cvt_pk_f16_f32 v94, |v68|, |v69|
  v_cvt_pk_f16_f32 v95, |v70|, |v71|
  v_mfma_f32_16x16x32_bf16 v[96:99], v[40:43], v[156:159], v[96:99]
  v_add_f32 v2, v100, v101
  v_fma_f32 v2, v2, s46, v1
  v_smfmac_f32_16x16x64_f16 v[96:99], v[44:47], v[88:95], v52
  v_exp_f32 v2, v2
  s_waitcnt vmcnt(0)
  v_mfma_f32_32x32x16_bf16 v[56:71], v[20:23], v[160:163], v[4:19]
  v_cvt_pk_f16_f32 v88, |v72|, |v73|
  v_cvt_pk_f16_f32 v89, |v74|, |v75|
  v_cvt_pk_f16_f32 v90, |v76|, |v77|
  v_mfma_f32_32x32x16_bf16 v[56:71], v[24:27], v[164:167], v[56:71]
  v_cvt_pk_f16_f32 v91, |v78|, |v79|
  v_cvt_pk_f16_f32 v92, |v80|, |v81|
  v_cvt_pk_f16_f32 v93, |v82|, |v83|
  v_cvt_pk_f16_f32 v94, |v84|, |v85|
  v_cvt_pk_f16_f32 v95, |v86|, |v87|
  v_mul_f32 v3, v2, v102
  ds_write_b64 v0, v[2:3] offset:1280
  v_smfmac_f32_16x16x64_f16 v[96:99], v[48:51], v[88:95], v52
  v_mfma_f32_16x16x32_bf16 v[100:103], v[36:39], v[160:163], 0
  ds_read_b128 v[20:23], v53 offset:4096
  ds_read_b128 v[24:27], v53 offset:5120
  v_mfma_f32_32x32x16_bf16 v[72:87], v[28:31], v[160:163], v[4:19]
  v_cvt_pk_f16_f32 v88, |v56|, |v57|
  v_cvt_pk_f16_f32 v89, |v58|, |v59|
  v_cvt_pk_f16_f32 v90, |v60|, |v61|
  v_mfma_f32_32x32x16_bf16 v[72:87], v[32:35], v[164:167], v[72:87]
  v_cvt_pk_f16_f32 v91, |v62|, |v63|
  v_cvt_pk_f16_f32 v92, |v64|, |v65|
  v_cvt_pk_f16_f32 v93, |v66|, |v67|
  v_cvt_pk_f16_f32 v94, |v68|, |v69|
  v_cvt_pk_f16_f32 v95, |v70|, |v71|
  v_mfma_f32_16x16x32_bf16 v[100:103], v[40:43], v[164:167], v[100:103]
  v_add_f32 v2, v96, v97
  v_fma_f32 v2, v2, s46, v1
  v_smfmac_f32_16x16x64_f16 v[100:103], v[44:47], v[88:95], v52
  v_exp_f32 v2, v2
  ds_read_b128 v[36:39], v53 offset:10240
  ds_read_b128 v[40:43], v53 offset:11264
  ds_read_b128 v[28:31], v53 offset:6144
  ds_read_b128 v[32:35], v53 offset:7168
  s_waitcnt lgkmcnt(4)
  v_mfma_f32_32x32x16_bf16 v[56:71], v[20:23], v[104:107], v[4:19]
  v_cvt_pk_f16_f32 v88, |v72|, |v73|
  v_cvt_pk_f16_f32 v89, |v74|, |v75|
  v_cvt_pk_f16_f32 v90, |v76|, |v77|
  v_mfma_f32_32x32x16_bf16 v[56:71], v[24:27], v[108:111], v[56:71]
  v_cvt_pk_f16_f32 v91, |v78|, |v79|
  v_cvt_pk_f16_f32 v92, |v80|, |v81|
  v_cvt_pk_f16_f32 v93, |v82|, |v83|
  v_cvt_pk_f16_f32 v94, |v84|, |v85|
  v_cvt_pk_f16_f32 v95, |v86|, |v87|
  v_mul_f32 v3, v2, v98
  ds_write_b64 v0, v[2:3] offset:1536
  v_smfmac_f32_16x16x64_f16 v[100:103], v[48:51], v[88:95], v52
  s_waitcnt lgkmcnt(3)
  v_mfma_f32_16x16x32_bf16 v[96:99], v[36:39], v[104:107], 0
  s_nop 1
  s_waitcnt lgkmcnt(0)
  v_mfma_f32_32x32x16_bf16 v[72:87], v[28:31], v[104:107], v[4:19]
  v_cvt_pk_f16_f32 v88, |v56|, |v57|
  v_cvt_pk_f16_f32 v89, |v58|, |v59|
  v_cvt_pk_f16_f32 v90, |v60|, |v61|
  v_mfma_f32_32x32x16_bf16 v[72:87], v[32:35], v[108:111], v[72:87]
  v_cvt_pk_f16_f32 v91, |v62|, |v63|
  v_cvt_pk_f16_f32 v92, |v64|, |v65|
  v_cvt_pk_f16_f32 v93, |v66|, |v67|
  v_cvt_pk_f16_f32 v94, |v68|, |v69|
  v_cvt_pk_f16_f32 v95, |v70|, |v71|
  v_mfma_f32_16x16x32_bf16 v[96:99], v[40:43], v[108:111], v[96:99]
  v_add_f32 v2, v100, v101
  v_fma_f32 v2, v2, s46, v1
  v_smfmac_f32_16x16x64_f16 v[96:99], v[44:47], v[88:95], v52
  v_exp_f32 v2, v2
  s_nop 0
  v_mfma_f32_32x32x16_bf16 v[56:71], v[20:23], v[112:115], v[4:19]
  v_cvt_pk_f16_f32 v88, |v72|, |v73|
  v_cvt_pk_f16_f32 v89, |v74|, |v75|
  v_cvt_pk_f16_f32 v90, |v76|, |v77|
  v_mfma_f32_32x32x16_bf16 v[56:71], v[24:27], v[116:119], v[56:71]
  v_cvt_pk_f16_f32 v91, |v78|, |v79|
  v_cvt_pk_f16_f32 v92, |v80|, |v81|
  v_cvt_pk_f16_f32 v93, |v82|, |v83|
  v_cvt_pk_f16_f32 v94, |v84|, |v85|
  v_cvt_pk_f16_f32 v95, |v86|, |v87|
  v_mul_f32 v3, v2, v102
  ds_write_b64 v0, v[2:3] offset:1792
  v_smfmac_f32_16x16x64_f16 v[96:99], v[48:51], v[88:95], v52
  v_mfma_f32_16x16x32_bf16 v[100:103], v[36:39], v[112:115], 0
  s_nop 1
  v_mfma_f32_32x32x16_bf16 v[72:87], v[28:31], v[112:115], v[4:19]
  v_cvt_pk_f16_f32 v88, |v56|, |v57|
  v_cvt_pk_f16_f32 v89, |v58|, |v59|
  v_cvt_pk_f16_f32 v90, |v60|, |v61|
  v_mfma_f32_32x32x16_bf16 v[72:87], v[32:35], v[116:119], v[72:87]
  v_cvt_pk_f16_f32 v91, |v62|, |v63|
  v_cvt_pk_f16_f32 v92, |v64|, |v65|
  v_cvt_pk_f16_f32 v93, |v66|, |v67|
  v_cvt_pk_f16_f32 v94, |v68|, |v69|
  v_cvt_pk_f16_f32 v95, |v70|, |v71|
  v_mfma_f32_16x16x32_bf16 v[100:103], v[40:43], v[116:119], v[100:103]
  v_add_f32 v2, v96, v97
  v_fma_f32 v2, v2, s46, v1
  v_smfmac_f32_16x16x64_f16 v[100:103], v[44:47], v[88:95], v52
  v_exp_f32 v2, v2
  s_nop 0
  v_mfma_f32_32x32x16_bf16 v[56:71], v[20:23], v[120:123], v[4:19]
  v_cvt_pk_f16_f32 v88, |v72|, |v73|
  v_cvt_pk_f16_f32 v89, |v74|, |v75|
  v_cvt_pk_f16_f32 v90, |v76|, |v77|
  v_mfma_f32_32x32x16_bf16 v[56:71], v[24:27], v[124:127], v[56:71]
  v_cvt_pk_f16_f32 v91, |v78|, |v79|
  v_cvt_pk_f16_f32 v92, |v80|, |v81|
  v_cvt_pk_f16_f32 v93, |v82|, |v83|
  v_cvt_pk_f16_f32 v94, |v84|, |v85|
  v_cvt_pk_f16_f32 v95, |v86|, |v87|
  v_mul_f32 v3, v2, v98
  ds_write_b64 v0, v[2:3] offset:16384
  v_smfmac_f32_16x16x64_f16 v[100:103], v[48:51], v[88:95], v52
  v_mfma_f32_16x16x32_bf16 v[96:99], v[36:39], v[120:123], 0
  s_nop 1
  v_mfma_f32_32x32x16_bf16 v[72:87], v[28:31], v[120:123], v[4:19]
  v_cvt_pk_f16_f32 v88, |v56|, |v57|
  v_cvt_pk_f16_f32 v89, |v58|, |v59|
  v_cvt_pk_f16_f32 v90, |v60|, |v61|
  v_mfma_f32_32x32x16_bf16 v[72:87], v[32:35], v[124:127], v[72:87]
  v_cvt_pk_f16_f32 v91, |v62|, |v63|
  v_cvt_pk_f16_f32 v92, |v64|, |v65|
  v_cvt_pk_f16_f32 v93, |v66|, |v67|
  v_cvt_pk_f16_f32 v94, |v68|, |v69|
  v_cvt_pk_f16_f32 v95, |v70|, |v71|
  v_mfma_f32_16x16x32_bf16 v[96:99], v[40:43], v[124:127], v[96:99]
  v_add_f32 v2, v100, v101
  v_fma_f32 v2, v2, s46, v1
  v_smfmac_f32_16x16x64_f16 v[96:99], v[44:47], v[88:95], v52
  v_exp_f32 v2, v2
  s_nop 0
  v_mfma_f32_32x32x16_bf16 v[56:71], v[20:23], v[128:131], v[4:19]
  v_cvt_pk_f16_f32 v88, |v72|, |v73|
  v_cvt_pk_f16_f32 v89, |v74|, |v75|
  v_cvt_pk_f16_f32 v90, |v76|, |v77|
  v_mfma_f32_32x32x16_bf16 v[56:71], v[24:27], v[132:135], v[56:71]
  v_cvt_pk_f16_f32 v91, |v78|, |v79|
  v_cvt_pk_f16_f32 v92, |v80|, |v81|
  v_cvt_pk_f16_f32 v93, |v82|, |v83|
  v_cvt_pk_f16_f32 v94, |v84|, |v85|
  v_cvt_pk_f16_f32 v95, |v86|, |v87|
  v_mul_f32 v3, v2, v102
  ds_write_b64 v0, v[2:3] offset:16640
  v_smfmac_f32_16x16x64_f16 v[96:99], v[48:51], v[88:95], v52
  v_mfma_f32_16x16x32_bf16 v[100:103], v[36:39], v[128:131], 0
  s_nop 1
  v_mfma_f32_32x32x16_bf16 v[72:87], v[28:31], v[128:131], v[4:19]
  v_cvt_pk_f16_f32 v88, |v56|, |v57|
  v_cvt_pk_f16_f32 v89, |v58|, |v59|
  v_cvt_pk_f16_f32 v90, |v60|, |v61|
  v_mfma_f32_32x32x16_bf16 v[72:87], v[32:35], v[132:135], v[72:87]
  v_cvt_pk_f16_f32 v91, |v62|, |v63|
  v_cvt_pk_f16_f32 v92, |v64|, |v65|
  v_cvt_pk_f16_f32 v93, |v66|, |v67|
  v_cvt_pk_f16_f32 v94, |v68|, |v69|
  v_cvt_pk_f16_f32 v95, |v70|, |v71|
  v_mfma_f32_16x16x32_bf16 v[100:103], v[40:43], v[132:135], v[100:103]
  v_add_f32 v2, v96, v97
  v_fma_f32 v2, v2, s46, v1
  v_smfmac_f32_16x16x64_f16 v[100:103], v[44:47], v[88:95], v52
  v_exp_f32 v2, v2
  s_nop 0
  v_mfma_f32_32x32x16_bf16 v[56:71], v[20:23], v[136:139], v[4:19]
  v_cvt_pk_f16_f32 v88, |v72|, |v73|
  v_cvt_pk_f16_f32 v89, |v74|, |v75|
  v_cvt_pk_f16_f32 v90, |v76|, |v77|
  v_mfma_f32_32x32x16_bf16 v[56:71], v[24:27], v[140:143], v[56:71]
  v_cvt_pk_f16_f32 v91, |v78|, |v79|
  v_cvt_pk_f16_f32 v92, |v80|, |v81|
  v_cvt_pk_f16_f32 v93, |v82|, |v83|
  v_cvt_pk_f16_f32 v94, |v84|, |v85|
  v_cvt_pk_f16_f32 v95, |v86|, |v87|
  v_mul_f32 v3, v2, v98
  ds_write_b64 v0, v[2:3] offset:16896
  v_smfmac_f32_16x16x64_f16 v[100:103], v[48:51], v[88:95], v52
  v_mfma_f32_16x16x32_bf16 v[96:99], v[36:39], v[136:139], 0
  s_nop 1
  v_mfma_f32_32x32x16_bf16 v[72:87], v[28:31], v[136:139], v[4:19]
  v_cvt_pk_f16_f32 v88, |v56|, |v57|
  v_cvt_pk_f16_f32 v89, |v58|, |v59|
  v_cvt_pk_f16_f32 v90, |v60|, |v61|
  v_mfma_f32_32x32x16_bf16 v[72:87], v[32:35], v[140:143], v[72:87]
  v_cvt_pk_f16_f32 v91, |v62|, |v63|
  v_cvt_pk_f16_f32 v92, |v64|, |v65|
  v_cvt_pk_f16_f32 v93, |v66|, |v67|
  v_cvt_pk_f16_f32 v94, |v68|, |v69|
  v_cvt_pk_f16_f32 v95, |v70|, |v71|
  v_mfma_f32_16x16x32_bf16 v[96:99], v[40:43], v[140:143], v[96:99]
  v_add_f32 v2, v100, v101
  v_fma_f32 v2, v2, s46, v1
  v_smfmac_f32_16x16x64_f16 v[96:99], v[44:47], v[88:95], v52
  v_exp_f32 v2, v2
  s_nop 0
  v_mfma_f32_32x32x16_bf16 v[56:71], v[20:23], v[144:147], v[4:19]
  v_cvt_pk_f16_f32 v88, |v72|, |v73|
  v_cvt_pk_f16_f32 v89, |v74|, |v75|
  v_cvt_pk_f16_f32 v90, |v76|, |v77|
  v_mfma_f32_32x32x16_bf16 v[56:71], v[24:27], v[148:151], v[56:71]
  v_cvt_pk_f16_f32 v91, |v78|, |v79|
  v_cvt_pk_f16_f32 v92, |v80|, |v81|
  v_cvt_pk_f16_f32 v93, |v82|, |v83|
  v_cvt_pk_f16_f32 v94, |v84|, |v85|
  v_cvt_pk_f16_f32 v95, |v86|, |v87|
  v_mul_f32 v3, v2, v102
  ds_write_b64 v0, v[2:3] offset:17152
  v_smfmac_f32_16x16x64_f16 v[96:99], v[48:51], v[88:95], v52
  v_mfma_f32_16x16x32_bf16 v[100:103], v[36:39], v[144:147], 0
  s_nop 1
  v_mfma_f32_32x32x16_bf16 v[72:87], v[28:31], v[144:147], v[4:19]
  v_cvt_pk_f16_f32 v88, |v56|, |v57|
  v_cvt_pk_f16_f32 v89, |v58|, |v59|
  v_cvt_pk_f16_f32 v90, |v60|, |v61|
  v_mfma_f32_32x32x16_bf16 v[72:87], v[32:35], v[148:151], v[72:87]
  v_cvt_pk_f16_f32 v91, |v62|, |v63|
  v_cvt_pk_f16_f32 v92, |v64|, |v65|
  v_cvt_pk_f16_f32 v93, |v66|, |v67|
  v_cvt_pk_f16_f32 v94, |v68|, |v69|
  v_cvt_pk_f16_f32 v95, |v70|, |v71|
  v_mfma_f32_16x16x32_bf16 v[100:103], v[40:43], v[148:151], v[100:103]
  v_add_f32 v2, v96, v97
  v_fma_f32 v2, v2, s46, v1
  v_smfmac_f32_16x16x64_f16 v[100:103], v[44:47], v[88:95], v52
  v_exp_f32 v2, v2
  s_nop 0
  v_mfma_f32_32x32x16_bf16 v[56:71], v[20:23], v[152:155], v[4:19]
  v_cvt_pk_f16_f32 v88, |v72|, |v73|
  v_cvt_pk_f16_f32 v89, |v74|, |v75|
  v_cvt_pk_f16_f32 v90, |v76|, |v77|
  v_mfma_f32_32x32x16_bf16 v[56:71], v[24:27], v[156:159], v[56:71]
  v_cvt_pk_f16_f32 v91, |v78|, |v79|
  v_cvt_pk_f16_f32 v92, |v80|, |v81|
  v_cvt_pk_f16_f32 v93, |v82|, |v83|
  v_cvt_pk_f16_f32 v94, |v84|, |v85|
  v_cvt_pk_f16_f32 v95, |v86|, |v87|
  v_mul_f32 v3, v2, v98
  ds_write_b64 v0, v[2:3] offset:17408
  v_smfmac_f32_16x16x64_f16 v[100:103], v[48:51], v[88:95], v52
  v_mfma_f32_16x16x32_bf16 v[96:99], v[36:39], v[152:155], 0
  s_nop 1
  v_mfma_f32_32x32x16_bf16 v[72:87], v[28:31], v[152:155], v[4:19]
  v_cvt_pk_f16_f32 v88, |v56|, |v57|
  v_cvt_pk_f16_f32 v89, |v58|, |v59|
  v_cvt_pk_f16_f32 v90, |v60|, |v61|
  v_mfma_f32_32x32x16_bf16 v[72:87], v[32:35], v[156:159], v[72:87]
  v_cvt_pk_f16_f32 v91, |v62|, |v63|
  v_cvt_pk_f16_f32 v92, |v64|, |v65|
  v_cvt_pk_f16_f32 v93, |v66|, |v67|
  v_cvt_pk_f16_f32 v94, |v68|, |v69|
  v_cvt_pk_f16_f32 v95, |v70|, |v71|
  v_mfma_f32_16x16x32_bf16 v[96:99], v[40:43], v[156:159], v[96:99]
  v_add_f32 v2, v100, v101
  v_fma_f32 v2, v2, s46, v1
  v_smfmac_f32_16x16x64_f16 v[96:99], v[44:47], v[88:95], v52
  v_exp_f32 v2, v2
  s_nop 0
  v_mfma_f32_32x32x16_bf16 v[56:71], v[20:23], v[160:163], v[4:19]
  v_cvt_pk_f16_f32 v88, |v72|, |v73|
  v_cvt_pk_f16_f32 v89, |v74|, |v75|
  v_cvt_pk_f16_f32 v90, |v76|, |v77|
  v_mfma_f32_32x32x16_bf16 v[56:71], v[24:27], v[164:167], v[56:71]
  v_cvt_pk_f16_f32 v91, |v78|, |v79|
  v_cvt_pk_f16_f32 v92, |v80|, |v81|
  v_cvt_pk_f16_f32 v93, |v82|, |v83|
  v_cvt_pk_f16_f32 v94, |v84|, |v85|
  v_cvt_pk_f16_f32 v95, |v86|, |v87|
  v_mul_f32 v3, v2, v102
  ds_write_b64 v0, v[2:3] offset:17664
  v_smfmac_f32_16x16x64_f16 v[96:99], v[48:51], v[88:95], v52
  v_mfma_f32_16x16x32_bf16 v[100:103], v[36:39], v[160:163], 0
  s_nop 1
  v_mfma_f32_32x32x16_bf16 v[72:87], v[28:31], v[160:163], v[4:19]
  v_cvt_pk_f16_f32 v88, |v56|, |v57|
  v_cvt_pk_f16_f32 v89, |v58|, |v59|
  v_cvt_pk_f16_f32 v90, |v60|, |v61|
  v_mfma_f32_32x32x16_bf16 v[72:87], v[32:35], v[164:167], v[72:87]
  v_cvt_pk_f16_f32 v91, |v62|, |v63|
  v_cvt_pk_f16_f32 v92, |v64|, |v65|
  v_cvt_pk_f16_f32 v93, |v66|, |v67|
  v_cvt_pk_f16_f32 v94, |v68|, |v69|
  v_cvt_pk_f16_f32 v95, |v70|, |v71|
  v_mfma_f32_16x16x32_bf16 v[100:103], v[40:43], v[164:167], v[100:103]
  v_add_f32 v2, v96, v97
  v_fma_f32 v2, v2, s46, v1
  v_smfmac_f32_16x16x64_f16 v[100:103], v[44:47], v[88:95], v52
  v_exp_f32 v2, v2
  s_nop 0
  s_nop 0
  v_cvt_pk_f16_f32 v88, |v72|, |v73|
  v_cvt_pk_f16_f32 v89, |v74|, |v75|
  v_cvt_pk_f16_f32 v90, |v76|, |v77|
  v_cvt_pk_f16_f32 v91, |v78|, |v79|
  v_cvt_pk_f16_f32 v92, |v80|, |v81|
  v_cvt_pk_f16_f32 v93, |v82|, |v83|
  v_cvt_pk_f16_f32 v94, |v84|, |v85|
  v_cvt_pk_f16_f32 v95, |v86|, |v87|
  v_mul_f32 v3, v2, v98
  ds_write_b64 v0, v[2:3] offset:17920
  v_smfmac_f32_16x16x64_f16 v[100:103], v[48:51], v[88:95], v52
  s_nop 7
  v_add_f32 v2, v100, v101
  v_fma_f32 v2, v2, s46, v1
  v_exp_f32 v2, v2
  s_nop 0
  v_mul_f32 v3, v2, v102
  ds_write_b64 v0, v[2:3] offset:18176
  v_mov_b32 v4, 0
  v_mov_b32 v5, 0
  s_cmp_eq_u32 s21, 3
  s_cbranch_scc0 L_Tnoz
  s_mov_b64 exec, s[50:51]
  ds_write_b64 v0, v[4:5] offset:1792
  ds_write_b64 v0, v[4:5] offset:18176
  s_mov_b64 exec, -1
L_Tnoz:
  v_mov_b32 v5, 1
  s_mov_b64 exec, 1
  ds_add_u32 v4, v5 offset:62480
  s_mov_b64 exec, -1
  s_endpgm
L_slow:
  s_mov_b64 s[66:67], s[50:51]
  s_load_dwordx4 s[4:7], s[0:1], 0
  s_load_dwordx4 s[8:11], s[0:1], 16
  s_load_dwordx4 s[12:15], s[0:1], 32
  s_load_dwordx4 s[16:19], s[0:1], 48
  s_load_dwordx2 s[20:21], s[0:1], 64
  s_waitcnt lgkmcnt(0) vmcnt(0)
  s_mov_b32 s24, s4
  s_and_b32 s25, s5, 0xffff
  s_mov_b32 s26, 1703936
  s_mov_b32 s27, 0x00020000
  s_mov_b32 s28, s6
  s_and_b32 s29, s7, 0xffff
  s_mov_b32 s30, 64000
  s_mov_b32 s31, 0x00020000
  s_mov_b32 s32, s8
  s_and_b32 s33, s9, 0xffff
  s_mov_b32 s34, 1300
  s_mov_b32 s35, 0x00020000
  s_mov_b32 s36, s10
  s_and_b32 s37, s11, 0xffff
  s_mov_b32 s38, 1300
  s_mov_b32 s39, 0x00020000
  s_mov_b32 s40, s12
  s_and_b32 s41, s13, 0xffff
  s_mov_b32 s42, 2048
  s_mov_b32 s43, 0x00020000
  s_mov_b32 s44, s14
  s_and_b32 s45, s15, 0xffff
  s_mov_b32 s46, 64
  s_mov_b32 s47, 0x00020000
  s_mov_b32 s48, s16
  s_and_b32 s49, s17, 0xffff
  s_mov_b32 s50, 64
  s_mov_b32 s51, 0x00020000
  s_mov_b32 s52, s18
  s_and_b32 s53, s19, 0xffff
  s_mov_b32 s54, 64
  s_mov_b32 s55, 0x00020000
  s_mov_b32 s56, s20
  s_and_b32 s57, s21, 0xffff
  s_mov_b32 s58, 32768
  s_mov_b32 s59, 0x00020000
  v_mov_b32 v7, v1
  v_lshlrev_b32 v1, 1, v7
  buffer_load_ushort v4, v1, s[44:47], 0 offen
  buffer_load_ushort v5, v1, s[48:51], 0 offen
  buffer_load_ushort v6, v1, s[52:55], 0 offen
  v_lshlrev_b32 v8, 2, v7
  buffer_load_dword v10, v8, s[32:35], 0 offen offset:0
  buffer_load_dword v16, v8, s[36:39], 0 offen offset:0
  buffer_load_dword v11, v8, s[32:35], 0 offen offset:256
  buffer_load_dword v17, v8, s[36:39], 0 offen offset:256
  buffer_load_dword v12, v8, s[32:35], 0 offen offset:512
  buffer_load_dword v18, v8, s[36:39], 0 offen offset:512
  buffer_load_dword v13, v8, s[32:35], 0 offen offset:768
  buffer_load_dword v19, v8, s[36:39], 0 offen offset:768
  buffer_load_dword v14, v8, s[32:35], 0 offen offset:1024
  buffer_load_dword v20, v8, s[36:39], 0 offen offset:1024
  buffer_load_dword v15, v8, s[32:35], 0 offen offset:1280
  buffer_load_dword v21, v8, s[36:39], 0 offen offset:1280
  v_lshlrev_b32 v1, 3, v7
  v_lshrrev_b32 v22, 3, v7
  v_and_b32 v23, 7, v7
  v_lshlrev_b32 v23, 9, v23
  v_lshl_add_u32 v23, v22, 2, v23
  buffer_load_dwordx2 v[2:3], v1, s[40:43], 0 offen offset:0
  s_waitcnt vmcnt(0)
  v_lshlrev_b32 v24, 16, v2
  v_and_b32 v25, 0xffff0000, v2
  v_lshlrev_b32 v26, 16, v3
  v_and_b32 v27, 0xffff0000, v3
  ds_write_b32 v23, v24 offset:0
  ds_write_b32 v23, v25 offset:128
  ds_write_b32 v23, v26 offset:256
  ds_write_b32 v23, v27 offset:384
  buffer_load_dwordx2 v[2:3], v1, s[40:43], 0 offen offset:512
  s_waitcnt vmcnt(0)
  v_lshlrev_b32 v24, 16, v2
  v_and_b32 v25, 0xffff0000, v2
  v_lshlrev_b32 v26, 16, v3
  v_and_b32 v27, 0xffff0000, v3
  ds_write_b32 v23, v24 offset:32
  ds_write_b32 v23, v25 offset:160
  ds_write_b32 v23, v26 offset:288
  ds_write_b32 v23, v27 offset:416
  buffer_load_dwordx2 v[2:3], v1, s[40:43], 0 offen offset:1024
  s_waitcnt vmcnt(0)
  v_lshlrev_b32 v24, 16, v2
  v_and_b32 v25, 0xffff0000, v2
  v_lshlrev_b32 v26, 16, v3
  v_and_b32 v27, 0xffff0000, v3
  ds_write_b32 v23, v24 offset:64
  ds_write_b32 v23, v25 offset:192
  ds_write_b32 v23, v26 offset:320
  ds_write_b32 v23, v27 offset:448
  buffer_load_dwordx2 v[2:3], v1, s[40:43], 0 offen offset:1536
  s_waitcnt vmcnt(0)
  v_lshlrev_b32 v24, 16, v2
  v_and_b32 v25, 0xffff0000, v2
  v_lshlrev_b32 v26, 16, v3
  v_and_b32 v27, 0xffff0000, v3
  ds_write_b32 v23, v24 offset:96
  ds_write_b32 v23, v25 offset:224
  ds_write_b32 v23, v26 offset:352
  ds_write_b32 v23, v27 offset:480
  v_lshlrev_b32 v4, 16, v4
  v_lshlrev_b32 v5, 16, v5
  v_lshlrev_b32 v6, 16, v6
  s_mov_b64 exec, 0xffffffff
  v_lshlrev_b32 v23, 3, v7
  v_lshlrev_b32 v24, 2, v7
  ds_write_b64 v23, v[4:5] offset:4096
  ds_write_b32 v24, v6 offset:4352
  s_mov_b64 exec, -1
  s_waitcnt lgkmcnt(0)
  v_mov_b32 v9, 0
  v_lshlrev_b32 v10, 2, v10
  v_lshlrev_b32 v16, 2, v16
  v_lshlrev_b32 v11, 2, v11
  v_lshlrev_b32 v17, 2, v17
  v_lshlrev_b32 v12, 2, v12
  v_lshlrev_b32 v18, 2, v18
  v_lshlrev_b32 v13, 2, v13
  v_lshlrev_b32 v19, 2, v19
  v_lshlrev_b32 v14, 2, v14
  v_lshlrev_b32 v20, 2, v20
  v_lshlrev_b32 v15, 2, v15
  v_lshlrev_b32 v21, 2, v21
S_row:
  s_ff1_i32_b64 s62, s[66:67]
  s_bitset0_b64 s[66:67], s62
  s_lshl_b32 s63, s2, 6
  s_add_u32 s62, s62, s63
  s_mul_i32 s64, s62, 104
  s_mov_b32 s68, 0
S_rnd:
  buffer_load_dword v22, v10, s[24:27], s64 offen
  buffer_load_dword v23, v16, s[24:27], s64 offen
  s_waitcnt vmcnt(0)
  v_lshlrev_b32 v22, 6, v22
  v_lshlrev_b32 v23, 6, v23
  buffer_load_dwordx4 v[24:27], v22, s[28:31], 0 offen offset:0
  buffer_load_dwordx4 v[40:43], v23, s[28:31], 0 offen offset:0
  buffer_load_dwordx4 v[28:31], v22, s[28:31], 0 offen offset:16
  buffer_load_dwordx4 v[44:47], v23, s[28:31], 0 offen offset:16
  buffer_load_dwordx4 v[32:35], v22, s[28:31], 0 offen offset:32
  buffer_load_dwordx4 v[48:51], v23, s[28:31], 0 offen offset:32
  buffer_load_dwordx4 v[36:39], v22, s[28:31], 0 offen offset:48
  buffer_load_dwordx4 v[52:55], v23, s[28:31], 0 offen offset:48
  s_waitcnt vmcnt(0)
  v_lshlrev_b32 v22, 16, v24
  v_lshlrev_b32 v23, 16, v40
  v_mul_f32 v56, v22, v23
  v_and_b32 v22, 0xffff0000, v24
  v_and_b32 v23, 0xffff0000, v40
  v_mul_f32 v57, v22, v23
  v_lshlrev_b32 v22, 16, v25
  v_lshlrev_b32 v23, 16, v41
  v_mul_f32 v58, v22, v23
  v_and_b32 v22, 0xffff0000, v25
  v_and_b32 v23, 0xffff0000, v41
  v_mul_f32 v59, v22, v23
  v_lshlrev_b32 v22, 16, v26
  v_lshlrev_b32 v23, 16, v42
  v_mul_f32 v60, v22, v23
  v_and_b32 v22, 0xffff0000, v26
  v_and_b32 v23, 0xffff0000, v42
  v_mul_f32 v61, v22, v23
  v_lshlrev_b32 v22, 16, v27
  v_lshlrev_b32 v23, 16, v43
  v_mul_f32 v62, v22, v23
  v_and_b32 v22, 0xffff0000, v27
  v_and_b32 v23, 0xffff0000, v43
  v_mul_f32 v63, v22, v23
  v_lshlrev_b32 v22, 16, v28
  v_lshlrev_b32 v23, 16, v44
  v_mul_f32 v64, v22, v23
  v_and_b32 v22, 0xffff0000, v28
  v_and_b32 v23, 0xffff0000, v44
  v_mul_f32 v65, v22, v23
  v_lshlrev_b32 v22, 16, v29
  v_lshlrev_b32 v23, 16, v45
  v_mul_f32 v66, v22, v23
  v_and_b32 v22, 0xffff0000, v29
  v_and_b32 v23, 0xffff0000, v45
  v_mul_f32 v67, v22, v23
  v_lshlrev_b32 v22, 16, v30
  v_lshlrev_b32 v23, 16, v46
  v_mul_f32 v68, v22, v23
  v_and_b32 v22, 0xffff0000, v30
  v_and_b32 v23, 0xffff0000, v46
  v_mul_f32 v69, v22, v23
  v_lshlrev_b32 v22, 16, v31
  v_lshlrev_b32 v23, 16, v47
  v_mul_f32 v70, v22, v23
  v_and_b32 v22, 0xffff0000, v31
  v_and_b32 v23, 0xffff0000, v47
  v_mul_f32 v71, v22, v23
  v_lshlrev_b32 v22, 16, v32
  v_lshlrev_b32 v23, 16, v48
  v_mul_f32 v72, v22, v23
  v_and_b32 v22, 0xffff0000, v32
  v_and_b32 v23, 0xffff0000, v48
  v_mul_f32 v73, v22, v23
  v_lshlrev_b32 v22, 16, v33
  v_lshlrev_b32 v23, 16, v49
  v_mul_f32 v74, v22, v23
  v_and_b32 v22, 0xffff0000, v33
  v_and_b32 v23, 0xffff0000, v49
  v_mul_f32 v75, v22, v23
  v_lshlrev_b32 v22, 16, v34
  v_lshlrev_b32 v23, 16, v50
  v_mul_f32 v76, v22, v23
  v_and_b32 v22, 0xffff0000, v34
  v_and_b32 v23, 0xffff0000, v50
  v_mul_f32 v77, v22, v23
  v_lshlrev_b32 v22, 16, v35
  v_lshlrev_b32 v23, 16, v51
  v_mul_f32 v78, v22, v23
  v_and_b32 v22, 0xffff0000, v35
  v_and_b32 v23, 0xffff0000, v51
  v_mul_f32 v79, v22, v23
  v_lshlrev_b32 v22, 16, v36
  v_lshlrev_b32 v23, 16, v52
  v_mul_f32 v80, v22, v23
  v_and_b32 v22, 0xffff0000, v36
  v_and_b32 v23, 0xffff0000, v52
  v_mul_f32 v81, v22, v23
  v_lshlrev_b32 v22, 16, v37
  v_lshlrev_b32 v23, 16, v53
  v_mul_f32 v82, v22, v23
  v_and_b32 v22, 0xffff0000, v37
  v_and_b32 v23, 0xffff0000, v53
  v_mul_f32 v83, v22, v23
  v_lshlrev_b32 v22, 16, v38
  v_lshlrev_b32 v23, 16, v54
  v_mul_f32 v84, v22, v23
  v_and_b32 v22, 0xffff0000, v38
  v_and_b32 v23, 0xffff0000, v54
  v_mul_f32 v85, v22, v23
  v_lshlrev_b32 v22, 16, v39
  v_lshlrev_b32 v23, 16, v55
  v_mul_f32 v86, v22, v23
  v_and_b32 v22, 0xffff0000, v39
  v_and_b32 v23, 0xffff0000, v55
  v_mul_f32 v87, v22, v23
  ds_read_b128 v[24:27], v9 offset:4352
  ds_read_b128 v[28:31], v9 offset:4368
  ds_read_b128 v[32:35], v9 offset:4384
  ds_read_b128 v[36:39], v9 offset:4400
  ds_read_b128 v[40:43], v9 offset:4416
  ds_read_b128 v[44:47], v9 offset:4432
  ds_read_b128 v[48:51], v9 offset:4448
  ds_read_b128 v[52:55], v9 offset:4464
  s_waitcnt lgkmcnt(0)
  v_mul_f32 v95, v56, v24
  v_fmac_f32 v95, v57, v25
  v_fmac_f32 v95, v58, v26
  v_fmac_f32 v95, v59, v27
  v_fmac_f32 v95, v60, v28
  v_fmac_f32 v95, v61, v29
  v_fmac_f32 v95, v62, v30
  v_fmac_f32 v95, v63, v31
  v_fmac_f32 v95, v64, v32
  v_fmac_f32 v95, v65, v33
  v_fmac_f32 v95, v66, v34
  v_fmac_f32 v95, v67, v35
  v_fmac_f32 v95, v68, v36
  v_fmac_f32 v95, v69, v37
  v_fmac_f32 v95, v70, v38
  v_fmac_f32 v95, v71, v39
  v_fmac_f32 v95, v72, v40
  v_fmac_f32 v95, v73, v41
  v_fmac_f32 v95, v74, v42
  v_fmac_f32 v95, v75, v43
  v_fmac_f32 v95, v76, v44
  v_fmac_f32 v95, v77, v45
  v_fmac_f32 v95, v78, v46
  v_fmac_f32 v95, v79, v47
  v_fmac_f32 v95, v80, v48
  v_fmac_f32 v95, v81, v49
  v_fmac_f32 v95, v82, v50
  v_fmac_f32 v95, v83, v51
  v_fmac_f32 v95, v84, v52
  v_fmac_f32 v95, v85, v53
  v_fmac_f32 v95, v86, v54
  v_fmac_f32 v95, v87, v55
  v_mov_b32 v94, 0
  v_mov_b32 v90, 0
  v_mov_b32 v91, 4096
  s_mov_b32 s65, 0
S_a:
  ds_read_b128 v[24:27], v90 offset:0
  ds_read_b128 v[28:31], v90 offset:16
  ds_read_b128 v[32:35], v90 offset:32
  ds_read_b128 v[36:39], v90 offset:48
  ds_read_b128 v[40:43], v90 offset:64
  ds_read_b128 v[44:47], v90 offset:80
  ds_read_b128 v[48:51], v90 offset:96
  ds_read_b128 v[52:55], v90 offset:112
  ds_read_b64 v[92:93], v91
  s_waitcnt lgkmcnt(0)
  v_fmac_f32 v92, v56, v24
  v_fmac_f32 v92, v57, v25
  v_fmac_f32 v92, v58, v26
  v_fmac_f32 v92, v59, v27
  v_fmac_f32 v92, v60, v28
  v_fmac_f32 v92, v61, v29
  v_fmac_f32 v92, v62, v30
  v_fmac_f32 v92, v63, v31
  v_fmac_f32 v92, v64, v32
  v_fmac_f32 v92, v65, v33
  v_fmac_f32 v92, v66, v34
  v_fmac_f32 v92, v67, v35
  v_fmac_f32 v92, v68, v36
  v_fmac_f32 v92, v69, v37
  v_fmac_f32 v92, v70, v38
  v_fmac_f32 v92, v71, v39
  v_fmac_f32 v92, v72, v40
  v_fmac_f32 v92, v73, v41
  v_fmac_f32 v92, v74, v42
  v_fmac_f32 v92, v75, v43
  v_fmac_f32 v92, v76, v44
  v_fmac_f32 v92, v77, v45
  v_fmac_f32 v92, v78, v46
  v_fmac_f32 v92, v79, v47
  v_fmac_f32 v92, v80, v48
  v_fmac_f32 v92, v81, v49
  v_fmac_f32 v92, v82, v50
  v_fmac_f32 v92, v83, v51
  v_fmac_f32 v92, v84, v52
  v_fmac_f32 v92, v85, v53
  v_fmac_f32 v92, v86, v54
  v_fmac_f32 v92, v87, v55
  v_max_f32 v92, 0, v92
  v_fmac_f32 v94, v92, v93
  v_add_u32 v90, 128, v90
  v_add_u32 v91, 8, v91
  s_add_u32 s65, s65, 1
  s_cmp_lt_u32 s65, 32
  s_cbranch_scc1 S_a
  v_mov_b32 v100, v101
  v_mov_b32 v106, v107
  v_mov_b32 v101, v102
  v_mov_b32 v107, v108
  v_mov_b32 v102, v103
  v_mov_b32 v108, v109
  v_mov_b32 v103, v104
  v_mov_b32 v109, v110
  v_mov_b32 v104, v105
  v_mov_b32 v110, v111
  v_mov_b32 v105, v94
  v_mov_b32 v111, v95
  v_mov_b32 v22, v10
  v_mov_b32 v23, v16
  v_mov_b32 v10, v11
  v_mov_b32 v16, v17
  v_mov_b32 v11, v12
  v_mov_b32 v17, v18
  v_mov_b32 v12, v13
  v_mov_b32 v18, v19
  v_mov_b32 v13, v14
  v_mov_b32 v19, v20
  v_mov_b32 v14, v15
  v_mov_b32 v20, v21
  v_mov_b32 v15, v22
  v_mov_b32 v21, v23
  s_add_u32 s68, s68, 1
  s_cmp_lt_u32 s68, 6
  s_cbranch_scc1 S_rnd
  v_cmp_gt_u32 vcc, 5, v7
  v_mov_b32 v22, 0xff800000
  s_nop 1
  v_cndmask_b32 v105, v22, v105, vcc
  v_mov_b32 v22, 0
  v_cndmask_b32 v111, v22, v111, vcc
  v_max3_f32 v22, v100, v101, v102
  v_max3_f32 v22, v22, v103, v104
  v_max_f32 v22, v22, v105
  v_xor_b32 v23, 1, v7
  v_lshlrev_b32 v23, 2, v23
  ds_bpermute_b32 v24, v23, v22
  s_waitcnt lgkmcnt(0)
  v_max_f32 v22, v22, v24
  v_xor_b32 v23, 2, v7
  v_lshlrev_b32 v23, 2, v23
  ds_bpermute_b32 v24, v23, v22
  s_waitcnt lgkmcnt(0)
  v_max_f32 v22, v22, v24
  v_xor_b32 v23, 4, v7
  v_lshlrev_b32 v23, 2, v23
  ds_bpermute_b32 v24, v23, v22
  s_waitcnt lgkmcnt(0)
  v_max_f32 v22, v22, v24
  v_xor_b32 v23, 8, v7
  v_lshlrev_b32 v23, 2, v23
  ds_bpermute_b32 v24, v23, v22
  s_waitcnt lgkmcnt(0)
  v_max_f32 v22, v22, v24
  v_xor_b32 v23, 16, v7
  v_lshlrev_b32 v23, 2, v23
  ds_bpermute_b32 v24, v23, v22
  s_waitcnt lgkmcnt(0)
  v_max_f32 v22, v22, v24
  v_xor_b32 v23, 32, v7
  v_lshlrev_b32 v23, 2, v23
  ds_bpermute_b32 v24, v23, v22
  s_waitcnt lgkmcnt(0)
  v_max_f32 v22, v22, v24
  v_mov_b32 v25, 0
  v_mov_b32 v26, 0
  v_mov_b32 v27, 0x3fb8aa3b
  v_sub_f32 v24, v100, v22
  v_mul_f32 v24, v24, v27
  v_exp_f32 v24, v24
  s_nop 0
  v_add_f32 v25, v25, v24
  v_fmac_f32 v26, v24, v106
  v_sub_f32 v24, v101, v22
  v_mul_f32 v24, v24, v27
  v_exp_f32 v24, v24
  s_nop 0
  v_add_f32 v25, v25, v24
  v_fmac_f32 v26, v24, v107
  v_sub_f32 v24, v102, v22
  v_mul_f32 v24, v24, v27
  v_exp_f32 v24, v24
  s_nop 0
  v_add_f32 v25, v25, v24
  v_fmac_f32 v26, v24, v108
  v_sub_f32 v24, v103, v22
  v_mul_f32 v24, v24, v27
  v_exp_f32 v24, v24
  s_nop 0
  v_add_f32 v25, v25, v24
  v_fmac_f32 v26, v24, v109
  v_sub_f32 v24, v104, v22
  v_mul_f32 v24, v24, v27
  v_exp_f32 v24, v24
  s_nop 0
  v_add_f32 v25, v25, v24
  v_fmac_f32 v26, v24, v110
  v_sub_f32 v24, v105, v22
  v_mul_f32 v24, v24, v27
  v_exp_f32 v24, v24
  s_nop 0
  v_add_f32 v25, v25, v24
  v_fmac_f32 v26, v24, v111
  v_xor_b32 v23, 1, v7
  v_lshlrev_b32 v23, 2, v23
  ds_bpermute_b32 v24, v23, v25
  ds_bpermute_b32 v28, v23, v26
  s_waitcnt lgkmcnt(0)
  v_add_f32 v25, v25, v24
  v_add_f32 v26, v26, v28
  v_xor_b32 v23, 2, v7
  v_lshlrev_b32 v23, 2, v23
  ds_bpermute_b32 v24, v23, v25
  ds_bpermute_b32 v28, v23, v26
  s_waitcnt lgkmcnt(0)
  v_add_f32 v25, v25, v24
  v_add_f32 v26, v26, v28
  v_xor_b32 v23, 4, v7
  v_lshlrev_b32 v23, 2, v23
  ds_bpermute_b32 v24, v23, v25
  ds_bpermute_b32 v28, v23, v26
  s_waitcnt lgkmcnt(0)
  v_add_f32 v25, v25, v24
  v_add_f32 v26, v26, v28
  v_xor_b32 v23, 8, v7
  v_lshlrev_b32 v23, 2, v23
  ds_bpermute_b32 v24, v23, v25
  ds_bpermute_b32 v28, v23, v26
  s_waitcnt lgkmcnt(0)
  v_add_f32 v25, v25, v24
  v_add_f32 v26, v26, v28
  v_xor_b32 v23, 16, v7
  v_lshlrev_b32 v23, 2, v23
  ds_bpermute_b32 v24, v23, v25
  ds_bpermute_b32 v28, v23, v26
  s_waitcnt lgkmcnt(0)
  v_add_f32 v25, v25, v24
  v_add_f32 v26, v26, v28
  v_xor_b32 v23, 32, v7
  v_lshlrev_b32 v23, 2, v23
  ds_bpermute_b32 v24, v23, v25
  ds_bpermute_b32 v28, v23, v26
  s_waitcnt lgkmcnt(0)
  v_add_f32 v25, v25, v24
  v_add_f32 v26, v26, v28
  v_rcp_f32 v25, v25
  s_nop 0
  v_mul_f32 v26, v26, v25
  v_cvt_pk_bf16_f32 v26, v26, v26
  s_lshl_b32 s64, s62, 1
  s_mov_b64 exec, 1
  buffer_store_short v26, v9, s[56:59], s64 offen
  s_mov_b64 exec, -1
  s_cmp_lg_u64 s[66:67], 0
  s_cbranch_scc1 S_row
L_end:
  s_endpgm
.section .rodata,"a"
.p2align 6
.amdhsa_kernel standalone__factorization_afm__recsys_kernel
  .amdhsa_next_free_vgpr 168
  .amdhsa_next_free_sgpr 102
  .amdhsa_accum_offset 168
  .amdhsa_group_segment_fixed_size 0
  .amdhsa_kernarg_size 88
  .amdhsa_user_sgpr_count 2
  .amdhsa_user_sgpr_kernarg_segment_ptr 1
  .amdhsa_system_sgpr_workgroup_id_x 1
.end_amdhsa_kernel
```
